```python
import torch

def _softmax(x, axis=-1):
    return torch.softmax(x, dim=axis)
def _gelu(x):
    return torch.nn.functional.gelu(x, approximate="tanh")
def _silu(x):
    return torch.nn.functional.silu(x)
def _sigmoid(x):
    return torch.sigmoid(x)
def _layernorm(x, axis=-1, eps=1e-5):
    m = x.mean(dim=axis, keepdim=True)
    v = x.var(dim=axis, keepdim=True, unbiased=False)
    return (x - m) / torch.sqrt(v + eps)
def _scatter_add(tgt, idx, src, axis=0):
    return tgt.clone().index_add_(axis, idx, src)
def _segment_sum(src, seg, n):
    out = torch.zeros((n,) + src.shape[1:], dtype=src.dtype)
    return out.index_add_(0, seg, src)
def _pad(x, pw):
    flat = tuple(v for pair in reversed(pw) for v in pair)
    return torch.nn.functional.pad(x, flat)

kernel_name = 'gated_mix__grouped_kv_mqa__ssm_conv_s4__prompt'

def setup_inputs():

    _w = (lambda a: (lambda t: t.to(torch.bfloat16) if t.is_floating_point() else t)(torch.as_tensor(a)))
    def _A_setup():
        B, S, D, H = 1, 2048, 448, 16
        Dh = D // H
        return {
            "x": _w((lambda *s: torch.randn(*s, dtype=torch.bfloat16) * 0.05)(B, S, D)),
            "wq": _w((lambda *s: torch.randn(*s, dtype=torch.bfloat16) * 1.6)(D, H * Dh)),
            "wk": _w((lambda *s: torch.randn(*s, dtype=torch.bfloat16) * 1.6)(D, Dh)),
            "wv": _w((lambda *s: torch.randn(*s, dtype=torch.bfloat16) * 0.05)(D, Dh)),
            "wo": _w((lambda *s: torch.randn(*s, dtype=torch.bfloat16) * 0.05)(H * Dh, D)),
        }
    _A_in = _A_setup()

    def _B_setup():
        B, L, D, N = 1, 2048, 448, 256
        A_re = -(lambda _x: torch.exp(torch.as_tensor(_x)))((lambda *s: torch.randn(*s, dtype=torch.bfloat16) * 3.2)(D, N))
        A_im = torch.pi * (lambda *s: torch.randn(*s, dtype=torch.bfloat16) * 0.05)(D, N)
        B_re = (lambda *s: torch.randn(*s, dtype=torch.bfloat16) * 0.2)(D, N)
        B_im = (lambda *s: torch.randn(*s, dtype=torch.bfloat16) * 0.2)(D, N)
        C_re = (lambda *s: torch.randn(*s, dtype=torch.bfloat16) * 0.2)(D, N)
        C_im = (lambda *s: torch.randn(*s, dtype=torch.bfloat16) * 0.2)(D, N)
        log_dt = (lambda *s: torch.randn(*s, dtype=torch.bfloat16) * 0.05)(D) * 0.5 - 4.0
        Dskip = (lambda *s: torch.randn(*s, dtype=torch.bfloat16) * 0.1)(D)
        return {
            "u": _w((lambda *s: torch.randn(*s, dtype=torch.bfloat16) * 0.05)(B, L, D)),
            "A_re": _w(A_re),
            "A_im": _w(A_im),
            "B_re": _w(B_re),
            "B_im": _w(B_im),
            "C_re": _w(C_re),
            "C_im": _w(C_im),
            "log_dt": _w(log_dt),
            "Dskip": _w(Dskip),
        }
    _B_in = _B_setup()

    return {
        "A_x": _A_in["x"],
        "A_wq": _A_in["wq"],
        "A_wk": _A_in["wk"],
        "A_wv": _A_in["wv"],
        "A_wo": _A_in["wo"],
        "B_u": _B_in["u"],
        "B_A_re": _B_in["A_re"],
        "B_A_im": _B_in["A_im"],
        "B_B_re": _B_in["B_re"],
        "B_B_im": _B_in["B_im"],
        "B_C_re": _B_in["C_re"],
        "B_C_im": _B_in["C_im"],
        "B_log_dt": _B_in["log_dt"],
        "B_Dskip": _B_in["Dskip"],
        "gate_w": _w((lambda *s: torch.randn(*s, dtype=torch.bfloat16) * 0.05)(448) * 16.0),
    }

def reference(A_x, A_wq, A_wk, A_wv, A_wo, B_u, B_A_re, B_A_im, B_B_re, B_B_im, B_C_re, B_C_im, B_log_dt, B_Dskip, gate_w):
    def _A_ref(x, wq, wk, wv, wo):
        B, S, D = x.shape
        H = 16
        Dh = D // H
        q = (lambda x, *d: x.permute(*d))((x @ wq).reshape(B, S, H, Dh), 0, 2, 1, 3)
        k = x @ wk
        v = x @ wv
        scores = torch.einsum("bhqd,bkd->bhqk", q, k) * (Dh ** -0.5)
        p = _softmax(scores, axis=-1)
        o = torch.einsum("bhqk,bkd->bhqd", p, v)
        return (lambda x, *d: x.permute(*d))(o, 0, 2, 1, 3).reshape(B, S, H * Dh) @ wo

    def _B_ref(u, A_re, A_im, B_re, B_im, C_re, C_im, log_dt, Dskip):
        Bsz, L, D = u.shape
        dt = torch.exp(log_dt)[:, None]
        A = A_re + 1j * A_im
        Bc = B_re + 1j * B_im
        Cc = C_re + 1j * C_im
        logdA = dt * A
        dB = dt * Bc
        l = (lambda x, dt: x.to(dt))(torch.arange(L), A_re.dtype)
        P = torch.exp(logdA[:, :, None] * l[None, None, :])
        K = torch.einsum("dn,dnl,dn->dl", Cc, P, dB).real
        L2 = 2 * L
        Kp = _pad(K, ((0, 0), (0, L)))
        up = (lambda x, *d: x.permute(*d))(u, 0, 2, 1)
        up = _pad(up, ((0, 0), (0, 0), (0, L)))
        Kf = (lambda x, axes=(-2,-1): torch.fft.rfft2(x.float(), dim=axes))(Kp[:, None, :], axes=(-2, -1))
        Uf = (lambda x, axes=(-2,-1): torch.fft.rfft2(x.float(), dim=axes))(up[:, :, None, :], axes=(-2, -1))
        Yf = Uf * Kf[None, :, :, :]
        y = (lambda x, s, axes=(-2,-1): torch.fft.irfft2(x, s=s, dim=axes).to(torch.bfloat16))(Yf, (1, L2), axes=(-2, -1))[:, :, 0, :L]
        y = (lambda x, *d: x.permute(*d))(y, 0, 2, 1) + u * Dskip[None, None, :]
        return y

    x = A_x
    g = _sigmoid((x * gate_w).sum(-1, keepdims=True))
    a = _A_ref(x, A_wq, A_wk, A_wv, A_wo)
    b = _B_ref(x, B_A_re, B_A_im, B_B_re, B_B_im, B_C_re, B_C_im, B_log_dt, B_Dskip)
    return g * a + (1 - g) * b
```

```asm
; @launch grid=(256,1,1) block=(512,1,1) lds=163840
.amdgcn_target "amdgcn-amd-amdhsa--gfx950"
.text
.globl gated_mix__grouped_kv_mqa__ssm_conv_s4__prompt_kernel
.p2align 8
.type gated_mix__grouped_kv_mqa__ssm_conv_s4__prompt_kernel,@function
gated_mix__grouped_kv_mqa__ssm_conv_s4__prompt_kernel:
    s_cmp_ge_u32 s2, 256
    s_cbranch_scc1 BAIL
    s_getpc_b64 s[84:85]
    v_lshlrev_b32 v76, 7, v0
    v_min_u32 v76, CODE_END - gated_mix__grouped_kv_mqa__ssm_conv_s4__prompt_kernel - 64, v76
    v_mov_b32 v77, s85
    v_add_co_u32 v76, vcc, s84, v76
    v_addc_co_u32 v77, vcc, 0, v77, vcc
    global_load_dword v79, v[76:77], off
    s_load_dwordx16 s[8:23], s[0:1], 0
    s_load_dwordx16 s[24:39], s[0:1], 64
    s_load_dwordx4 s[40:43], s[0:1], 128
    v_lshrrev_b32 v2, 6, v0
    v_and_b32 v1, 63, v0
    v_readfirstlane_b32 s3, v2
    v_lshlrev_b32 v2, 4, v1
    v_mov_b32 v3, 0
    v_mov_b32 v4, 1
    s_and_b32 s4, s2, 7
    s_lshl_b32 s4, s4, 3
    s_bfe_u32 s5, s2, 0x30003
    s_add_u32 s4, s4, s5
    s_lshr_b32 s5, s2, 6
    s_mov_b32 s61, 262144
    s_mov_b32 s62, 0
    s_mov_b32 s63, -1
    s_cmp_lg_u32 s3, 0
    s_cbranch_scc1 NOZERO
    v_mov_b32 v8, 0
    v_mov_b32 v9, 0
    v_mov_b32 v10, 0
    v_mov_b32 v11, 0
    v_lshlrev_b32 v6, 3, v1
    v_add_u32 v7, 162816, v2
    ds_write_b64 v6, v[8:9] offset:18432
    ds_write_b128 v7, v[8:11]
NOZERO:
    s_waitcnt lgkmcnt(0)
    s_mov_b32 s44, s42
    s_mov_b32 s45, s43
    s_mov_b32 s46, 8650752
    s_mov_b32 s47, 0x00020000
    s_cmp_ge_u32 s3, 4
    s_cbranch_scc1 HELPER
    s_setprio 3
    s_lshr_b32 s64, s2, 3
    v_lshlrev_b32 v8, 7, v1
    s_mov_b32 s55, 0x00020000
    s_cmp_lg_u32 s3, 0
    s_cbranch_scc1 A_P1
    s_mov_b32 s52, s8
    s_mov_b32 s53, s9
    s_lshl_b32 s65, s4, 2
    s_add_u32 s65, s65, s5
    s_mul_i32 s65, s65, 7168
    s_add_u32 s54, s65, 7168
    s_branch A_PGO
A_P1:
    s_cmp_eq_u32 s3, 3
    s_cbranch_scc1 A_P3
    s_mov_b32 s52, s10
    s_mov_b32 s53, s11
    s_mul_i32 s65, s64, 12544
    s_add_u32 s54, s65, 12544
    s_cmp_eq_u32 s3, 1
    s_cselect_b32 s66, 0, 6272
    s_cselect_b32 s67, 6272, 0
    s_add_u32 s65, s65, s66
    s_sub_u32 s54, s54, s67
    s_branch A_PGO
A_P3:
    s_cmp_lt_u32 s64, 16
    s_cselect_b32 s52, s12, s14
    s_cselect_b32 s53, s13, s15
    s_and_b32 s65, s64, 15
    s_mul_i32 s65, s65, 1664
    s_add_u32 s54, s65, 1664
    s_min_u32 s54, s54, 25088
A_PGO:
    buffer_load_dword v79, v8, s[52:55], s65 offen
    s_barrier
    v_lshrrev_b32 v16, 5, v1
    v_and_b32 v17, 31, v1
    v_mul_u32_u24 v17, 912, v17
    v_lshl_add_u32 v17, v16, 4, v17
    v_add_u32 v78, 18944, v17
    v_lshrrev_b32 v16, 4, v1
    v_and_b32 v17, 15, v1
    v_lshlrev_b32 v16, 12, v16
    v_lshl_add_u32 v77, v17, 6, v16
    s_lshl_b32 s79, s3, 10
    s_add_u32 s79, s79, 278528
    s_cmp_ge_u32 s3, 2
    s_cbranch_scc1 A_DMAW
    s_mov_b32 s56, s36
    s_mov_b32 s57, s37
    s_mov_b32 s58, 896
    s_mov_b32 s59, 0x00020000
    buffer_load_dwordx4 v[12:15], v2, s[56:59], 0 offen
    s_and_b32 s74, s5, 1
    s_cmp_lt_u32 s5, 2
    s_cselect_b32 s65, s3, s74
    s_cselect_b32 s66, s74, s3
    s_cselect_b32 s67, 0, 2048
    s_lshl_b32 s65, s65, 10
    s_lshl_b32 s66, s66, 8
    s_lshl_b32 s68, s4, 12
    s_add_u32 s68, s68, s65
    s_add_u32 s68, s68, s66
    s_add_u32 s68, s68, s67
    v_lshrrev_b32 v16, 4, v1
    v_lshl_add_u32 v18, v16, 5, v17
    v_lshlrev_b32 v9, 4, v18
    v_mov_b32 v20, -1
    v_mov_b32 v21, -1
    v_mov_b32 v22, -1
    v_mov_b32 v23, -1
    s_mov_b32 exec_hi, 0
    buffer_store_dwordx4 v[20:23], v9, s[44:47], s68 offen sc1
    s_mov_b32 s48, s8
    s_mov_b32 s49, s9
    s_mov_b32 s50, 1835008
    s_mov_b32 s51, 0x00020000
    s_mul_i32 s64, s3, 14592
    s_add_u32 m0, s64, 18944
    s_lshl_b32 s65, s4, 5
    s_lshl_b32 s66, s3, 4
    s_add_u32 s65, s65, s66
    s_mul_i32 s65, s65, 896
    s_mov_b32 exec_hi, 0x00ffffff
    buffer_load_dwordx4 v2, s[48:51], s65 offen lds
    s_add_u32 m0, m0, 912
    s_add_u32 s65, s65, 896
    buffer_load_dwordx4 v2, s[48:51], s65 offen lds
    s_add_u32 m0, m0, 912
    s_add_u32 s65, s65, 896
    buffer_load_dwordx4 v2, s[48:51], s65 offen lds
    s_add_u32 m0, m0, 912
    s_add_u32 s65, s65, 896
    buffer_load_dwordx4 v2, s[48:51], s65 offen lds
    s_add_u32 m0, m0, 912
    s_add_u32 s65, s65, 896
    buffer_load_dwordx4 v2, s[48:51], s65 offen lds
    s_add_u32 m0, m0, 912
    s_add_u32 s65, s65, 896
    buffer_load_dwordx4 v2, s[48:51], s65 offen lds
    s_add_u32 m0, m0, 912
    s_add_u32 s65, s65, 896
    buffer_load_dwordx4 v2, s[48:51], s65 offen lds
    s_add_u32 m0, m0, 912
    s_add_u32 s65, s65, 896
    buffer_load_dwordx4 v2, s[48:51], s65 offen lds
    s_add_u32 m0, m0, 912
    s_add_u32 s65, s65, 896
    buffer_load_dwordx4 v2, s[48:51], s65 offen lds
    s_add_u32 m0, m0, 912
    s_add_u32 s65, s65, 896
    buffer_load_dwordx4 v2, s[48:51], s65 offen lds
    s_add_u32 m0, m0, 912
    s_add_u32 s65, s65, 896
    buffer_load_dwordx4 v2, s[48:51], s65 offen lds
    s_add_u32 m0, m0, 912
    s_add_u32 s65, s65, 896
    buffer_load_dwordx4 v2, s[48:51], s65 offen lds
    s_add_u32 m0, m0, 912
    s_add_u32 s65, s65, 896
    buffer_load_dwordx4 v2, s[48:51], s65 offen lds
    s_add_u32 m0, m0, 912
    s_add_u32 s65, s65, 896
    buffer_load_dwordx4 v2, s[48:51], s65 offen lds
    s_add_u32 m0, m0, 912
    s_add_u32 s65, s65, 896
    buffer_load_dwordx4 v2, s[48:51], s65 offen lds
    s_add_u32 m0, m0, 912
    s_add_u32 s65, s65, 896
    buffer_load_dwordx4 v2, s[48:51], s65 offen lds
    s_mov_b32 exec_hi, -1
    s_cmp_lt_u32 s5, 2
    s_cselect_b32 s52, s12, s14
    s_cselect_b32 s53, s13, s15
    s_mov_b32 s54, 25088
    s_mov_b32 s55, 0x00020000
    s_mul_i32 s65, s3, 13312
    s_add_u32 m0, s65, 134144
    s_nop 0
    buffer_load_dwordx4 v2, s[52:55], s65 offen lds
    s_add_u32 m0, m0, 1024
    s_add_u32 s65, s65, 1024
    buffer_load_dwordx4 v2, s[52:55], s65 offen lds
    s_add_u32 m0, m0, 1024
    s_add_u32 s65, s65, 1024
    buffer_load_dwordx4 v2, s[52:55], s65 offen lds
    s_add_u32 m0, m0, 1024
    s_add_u32 s65, s65, 1024
    buffer_load_dwordx4 v2, s[52:55], s65 offen lds
    s_add_u32 m0, m0, 1024
    s_add_u32 s65, s65, 1024
    buffer_load_dwordx4 v2, s[52:55], s65 offen lds
    s_add_u32 m0, m0, 1024
    s_add_u32 s65, s65, 1024
    buffer_load_dwordx4 v2, s[52:55], s65 offen lds
    s_add_u32 m0, m0, 1024
    s_add_u32 s65, s65, 1024
    buffer_load_dwordx4 v2, s[52:55], s65 offen lds
    s_add_u32 m0, m0, 1024
    s_add_u32 s65, s65, 1024
    buffer_load_dwordx4 v2, s[52:55], s65 offen lds
    s_add_u32 m0, m0, 1024
    s_add_u32 s65, s65, 1024
    buffer_load_dwordx4 v2, s[52:55], s65 offen lds
    s_add_u32 m0, m0, 1024
    s_add_u32 s65, s65, 1024
    buffer_load_dwordx4 v2, s[52:55], s65 offen lds
    s_add_u32 m0, m0, 1024
    s_add_u32 s65, s65, 1024
    buffer_load_dwordx4 v2, s[52:55], s65 offen lds
    s_add_u32 m0, m0, 1024
    s_add_u32 s65, s65, 1024
    buffer_load_dwordx4 v2, s[52:55], s65 offen lds
    s_add_u32 m0, m0, 1024
    s_add_u32 s65, s65, 1024
    buffer_load_dwordx4 v2, s[52:55], s65 offen lds
    s_mov_b64 exec, 1
    ds_add_u32 v3, v4 offset:18440
    s_mov_b64 exec, -1
    global_load_dword v30, v3, s[40:41] sc1
    v_and_b32 v16, 15, v1
    v_lshrrev_b32 v17, 4, v1
    s_lshl_b32 s65, s74, 4
    v_add_u32 v18, s65, v16
    v_mul_u32_u24 v18, 912, v18
    v_lshl_add_u32 v18, v17, 4, v18
    v_add_u32 v6, 18944, v18
    v_bfe_u32 v18, v1, 2, 2
    v_lshl_add_u32 v18, v17, 3, v18
    v_and_b32 v19, 3, v1
    v_lshlrev_b32 v19, 3, v19
    v_mad_u32_u24 v24, v18, 56, v19
    s_lshl_b32 s65, s3, 5
    s_add_u32 s65, s65, 134144
    v_add_u32 v7, s65, v24
    v_mul_u32_u24 v18, 912, v18
    v_add_u32 v10, v18, v19
    s_mul_i32 s65, s5, 224
    s_lshl_b32 s66, s3, 7
    s_add_u32 s65, s65, s66
    s_add_u32 s65, s65, 18944
    v_add_u32 v10, s65, v10
    v_lshrrev_b32 v18, 1, v16
    v_lshlrev_b32 v18, 13, v18
    v_and_b32 v19, 1, v1
    v_lshl_add_u32 v18, v19, 6, v18
    v_lshl_add_u32 v11, v17, 4, v18
    s_mul_i32 s65, s5, 56
    s_lshl_b32 s66, s3, 5
    s_add_u32 s65, s65, s66
    s_lshl_b32 s65, s65, 13
    s_lshl_b32 s66, s4, 7
    s_add_u32 s65, s65, s66
    s_add_u32 s69, s65, 524288
    s_lshl_b32 s65, s5, 6
    s_add_u32 s65, s65, s4
    s_lshl_b32 s65, s65, 6
    s_add_u32 s70, s65, 278528
    s_lshl_b32 s65, s4, 1
    s_add_u32 s65, s65, s74
    s_lshl_b32 s65, s65, 6
    s_add_u32 s71, s65, 262144
    s_mov_b32 s72, 1049335798
    s_mov_b32 s75, 0xfffffffe
    s_lshl_b32 s65, s5, 1
    s_add_u32 s65, s65, s3
    s_lshl_b32 s65, s65, 6
    s_add_u32 s65, s65, s4
    s_lshl_b32 s65, s65, 6
    s_add_u32 s83, s65, 294912
    v_accvgpr_write_b32 a0, 0
    v_accvgpr_write_b32 a1, 0
    v_accvgpr_write_b32 a2, 0
    v_accvgpr_write_b32 a3, 0
    v_accvgpr_write_b32 a4, 0
    v_accvgpr_write_b32 a5, 0
    v_accvgpr_write_b32 a6, 0
    v_accvgpr_write_b32 a7, 0
    v_accvgpr_write_b32 a8, 0
    v_accvgpr_write_b32 a9, 0
    v_accvgpr_write_b32 a10, 0
    v_accvgpr_write_b32 a11, 0
    v_accvgpr_write_b32 a12, 0
    v_accvgpr_write_b32 a13, 0
    v_accvgpr_write_b32 a14, 0
    v_accvgpr_write_b32 a15, 0
    v_accvgpr_write_b32 a16, 0
    v_accvgpr_write_b32 a17, 0
    v_accvgpr_write_b32 a18, 0
    v_accvgpr_write_b32 a19, 0
    v_accvgpr_write_b32 a20, 0
    v_accvgpr_write_b32 a21, 0
    v_accvgpr_write_b32 a22, 0
    v_accvgpr_write_b32 a23, 0
    v_accvgpr_write_b32 a24, 0
    v_accvgpr_write_b32 a25, 0
    v_accvgpr_write_b32 a26, 0
    v_accvgpr_write_b32 a27, 0
    v_accvgpr_write_b32 a28, 0
    v_accvgpr_write_b32 a29, 0
    v_accvgpr_write_b32 a30, 0
    v_accvgpr_write_b32 a31, 0
    v_accvgpr_write_b32 a32, 0
    v_accvgpr_write_b32 a33, 0
    v_accvgpr_write_b32 a34, 0
    v_accvgpr_write_b32 a35, 0
    v_accvgpr_write_b32 a36, 0
    v_accvgpr_write_b32 a37, 0
    v_accvgpr_write_b32 a38, 0
    v_accvgpr_write_b32 a39, 0
    v_accvgpr_write_b32 a40, 0
    v_accvgpr_write_b32 a41, 0
    v_accvgpr_write_b32 a42, 0
    v_accvgpr_write_b32 a43, 0
    v_accvgpr_write_b32 a44, 0
    v_accvgpr_write_b32 a45, 0
    v_accvgpr_write_b32 a46, 0
    v_accvgpr_write_b32 a47, 0
    v_accvgpr_write_b32 a48, 0
    v_accvgpr_write_b32 a49, 0
    v_accvgpr_write_b32 a50, 0
    v_accvgpr_write_b32 a51, 0
    v_accvgpr_write_b32 a52, 0
    v_accvgpr_write_b32 a53, 0
    v_accvgpr_write_b32 a54, 0
    v_accvgpr_write_b32 a55, 0
    v_accvgpr_write_b32 a56, 0
    v_accvgpr_write_b32 a57, 0
    v_accvgpr_write_b32 a58, 0
    v_accvgpr_write_b32 a59, 0
    v_accvgpr_write_b32 a60, 0
    v_accvgpr_write_b32 a61, 0
    v_accvgpr_write_b32 a62, 0
    v_accvgpr_write_b32 a63, 0
    s_waitcnt vmcnt(1)
    s_mov_b64 exec, 1
    ds_add_u32 v3, v4 offset:18432
    s_mov_b64 exec, -1
W1:
    ds_read_b32 v5, v3 offset:18432
    s_waitcnt lgkmcnt(0)
    v_readfirstlane_b32 s64, v5
    s_cmp_ge_u32 s64, 2
    s_cbranch_scc1 D2
    s_sub_u32 s61, s61, 1
    s_cbranch_scc1 BAIL
    s_sleep 1
    s_branch W1
D2:
    s_cmp_ge_u32 s5, 2
    s_cbranch_scc1 A_V
    ds_read_b128 v[84:87], v6 offset:0
    ds_read_b64_tr_b16 v[80:81], v7 offset:0
    ds_read_b64_tr_b16 v[82:83], v7 offset:224
    ds_read_b128 v[92:95], v6 offset:64
    ds_read_b64_tr_b16 v[88:89], v7 offset:1792
    ds_read_b64_tr_b16 v[90:91], v7 offset:2016
    ds_read_b128 v[100:103], v6 offset:128
    ds_read_b64_tr_b16 v[96:97], v7 offset:3584
    ds_read_b64_tr_b16 v[98:99], v7 offset:3808
    ds_read_b128 v[108:111], v6 offset:192
    ds_read_b64_tr_b16 v[104:105], v7 offset:5376
    ds_read_b64_tr_b16 v[106:107], v7 offset:5600
    ds_read_b128 v[116:119], v6 offset:256
    ds_read_b64_tr_b16 v[112:113], v7 offset:7168
    ds_read_b64_tr_b16 v[114:115], v7 offset:7392
    s_cmp_lg_u32 s3, 0
    s_cbranch_scc1 F3
    s_waitcnt vmcnt(0)
N4:
    v_readfirstlane_b32 s60, v30
    s_cmp_lg_u32 s60, 0
    s_cbranch_scc1 D5
    s_sub_u32 s61, s61, 1
    s_cbranch_scc1 BAIL
    global_load_dword v30, v3, s[40:41] sc1
    s_waitcnt vmcnt(0)
    s_branch N4
D5:
    s_mov_b64 exec, 1
    buffer_store_dword v30, v3, s[44:47], s70 offen sc1
    s_mov_b64 exec, -1
F3:
    s_waitcnt lgkmcnt(12)
    v_mfma_f32_16x16x32_bf16 v[16:19], v[80:83], v[84:87], 0
    ds_read_b128 v[124:127], v6 offset:320
    ds_read_b64_tr_b16 v[120:121], v7 offset:8960
    ds_read_b64_tr_b16 v[122:123], v7 offset:9184
    s_waitcnt lgkmcnt(12)
    v_mfma_f32_16x16x32_bf16 v[16:19], v[88:91], v[92:95], v[16:19]
    ds_read_b128 v[84:87], v6 offset:384
    ds_read_b64_tr_b16 v[80:81], v7 offset:10752
    ds_read_b64_tr_b16 v[82:83], v7 offset:10976
    s_waitcnt lgkmcnt(12)
    v_mfma_f32_16x16x32_bf16 v[16:19], v[96:99], v[100:103], v[16:19]
    ds_read_b128 v[92:95], v6 offset:448
    ds_read_b64_tr_b16 v[88:89], v7 offset:12544
    ds_read_b64_tr_b16 v[90:91], v7 offset:12768
    s_waitcnt lgkmcnt(12)
    v_mfma_f32_16x16x32_bf16 v[16:19], v[104:107], v[108:111], v[16:19]
    ds_read_b128 v[100:103], v6 offset:512
    ds_read_b64_tr_b16 v[96:97], v7 offset:14336
    ds_read_b64_tr_b16 v[98:99], v7 offset:14560
    s_waitcnt lgkmcnt(12)
    v_mfma_f32_16x16x32_bf16 v[16:19], v[112:115], v[116:119], v[16:19]
    ds_read_b128 v[108:111], v6 offset:576
    ds_read_b64_tr_b16 v[104:105], v7 offset:16128
    ds_read_b64_tr_b16 v[106:107], v7 offset:16352
    s_waitcnt lgkmcnt(12)
    v_mfma_f32_16x16x32_bf16 v[16:19], v[120:123], v[124:127], v[16:19]
    ds_read_b128 v[116:119], v6 offset:640
    ds_read_b64_tr_b16 v[112:113], v7 offset:17920
    ds_read_b64_tr_b16 v[114:115], v7 offset:18144
    s_waitcnt lgkmcnt(12)
    v_mfma_f32_16x16x32_bf16 v[16:19], v[80:83], v[84:87], v[16:19]
    ds_read_b128 v[124:127], v6 offset:704
    ds_read_b64_tr_b16 v[120:121], v7 offset:19712
    ds_read_b64_tr_b16 v[122:123], v7 offset:19936
    s_waitcnt lgkmcnt(12)
    v_mfma_f32_16x16x32_bf16 v[16:19], v[88:91], v[92:95], v[16:19]
    ds_read_b128 v[84:87], v6 offset:768
    ds_read_b64_tr_b16 v[80:81], v7 offset:21504
    ds_read_b64_tr_b16 v[82:83], v7 offset:21728
    s_waitcnt lgkmcnt(12)
    v_mfma_f32_16x16x32_bf16 v[16:19], v[96:99], v[100:103], v[16:19]
    ds_read_b128 v[92:95], v6 offset:832
    ds_read_b64_tr_b16 v[88:89], v7 offset:23296
    ds_read_b64_tr_b16 v[90:91], v7 offset:23520
    s_waitcnt lgkmcnt(12)
    v_mfma_f32_16x16x32_bf16 v[16:19], v[104:107], v[108:111], v[16:19]
    s_waitcnt lgkmcnt(9)
    v_mfma_f32_16x16x32_bf16 v[16:19], v[112:115], v[116:119], v[16:19]
    s_waitcnt lgkmcnt(6)
    v_mfma_f32_16x16x32_bf16 v[16:19], v[120:123], v[124:127], v[16:19]
    s_waitcnt lgkmcnt(3)
    v_mfma_f32_16x16x32_bf16 v[16:19], v[80:83], v[84:87], v[16:19]
    s_waitcnt lgkmcnt(0)
    v_mfma_f32_16x16x32_bf16 v[16:19], v[88:91], v[92:95], v[16:19]
    s_mov_b64 exec, 1
    ds_add_u32 v3, v4 offset:18452
    s_mov_b64 exec, -1
    s_mov_b32 s66, 0
    s_cmp_eq_u32 s3, 1
    s_cselect_b32 s67, 0xffff0000, 0
    v_mov_b32 v28, 0x3f803f80
    v_mov_b32 v29, 0x00003f80
    s_nop 1
    v_mul_f32 v16, s72, v16
    v_mul_f32 v17, s72, v17
    v_mul_f32 v18, s72, v18
    v_mul_f32 v19, s72, v19
    v_cvt_pk_bf16_f32 v24, v16, v17
    v_cvt_pk_bf16_f32 v25, v18, v19
    v_cndmask_b32 v24, v24, v28, s[66:67]
    v_cndmask_b32 v25, v25, v29, s[66:67]
    v_mov_b32 v26, v24
    v_mov_b32 v27, v25
    s_nop 1
    v_permlane32_swap_b32 v24, v26
    v_permlane32_swap_b32 v25, v27
    s_nop 0
    v_min_u32 v24, s75, v24
    s_mov_b32 exec_hi, 0
    buffer_store_dwordx4 v[24:27], v9, s[44:47], s68 offen sc1
    s_mov_b32 exec_hi, -1
    v_mul_f32 v28, v16, v16
    v_fmac_f32 v28, v17, v17
    v_fmac_f32 v28, v18, v18
    v_fmac_f32 v28, v19, v19
    v_cndmask_b32 v28, v28, 0, s[66:67]
    v_mov_b32 v29, v28
    s_nop 1
    v_permlane16_swap_b32 v28, v29
    s_nop 1
    v_add_f32 v28, v28, v29
    v_mov_b32 v29, v28
    s_nop 1
    v_permlane32_swap_b32 v28, v29
    v_lshlrev_b32 v8, 2, v1
    v_add_f32 v31, v28, v29
    s_cmp_eq_u32 s3, 1
    s_cbranch_scc1 A_KVFLAG
    ds_write_b32 v8, v31 offset:18688
    s_mov_b64 exec, 1
    ds_add_u32 v3, v4 offset:18504
    s_mov_b64 exec, -1
    s_branch A_KVFLAG
A_V:
    ds_read_b128 v[84:87], v6 offset:0
    ds_read_b64_tr_b16 v[80:81], v7 offset:0
    ds_read_b64_tr_b16 v[82:83], v7 offset:224
    ds_read_b128 v[92:95], v6 offset:64
    ds_read_b64_tr_b16 v[88:89], v7 offset:1792
    ds_read_b64_tr_b16 v[90:91], v7 offset:2016
    ds_read_b128 v[100:103], v6 offset:128
    ds_read_b64_tr_b16 v[96:97], v7 offset:3584
    ds_read_b64_tr_b16 v[98:99], v7 offset:3808
    ds_read_b128 v[108:111], v6 offset:192
    ds_read_b64_tr_b16 v[104:105], v7 offset:5376
    ds_read_b64_tr_b16 v[106:107], v7 offset:5600
    ds_read_b128 v[116:119], v6 offset:256
    ds_read_b64_tr_b16 v[112:113], v7 offset:7168
    ds_read_b64_tr_b16 v[114:115], v7 offset:7392
    s_cmp_lg_u32 s3, 0
    s_cbranch_scc1 F6
    s_waitcnt vmcnt(0)
N7:
    v_readfirstlane_b32 s60, v30
    s_cmp_lg_u32 s60, 0
    s_cbranch_scc1 D8
    s_sub_u32 s61, s61, 1
    s_cbranch_scc1 BAIL
    global_load_dword v30, v3, s[40:41] sc1
    s_waitcnt vmcnt(0)
    s_branch N7
D8:
    s_mov_b64 exec, 1
    buffer_store_dword v30, v3, s[44:47], s70 offen sc1
    s_mov_b64 exec, -1
F6:
    s_waitcnt lgkmcnt(12)
    v_mfma_f32_16x16x32_bf16 v[16:19], v[84:87], v[80:83], 0
    ds_read_b128 v[124:127], v6 offset:320
    ds_read_b64_tr_b16 v[120:121], v7 offset:8960
    ds_read_b64_tr_b16 v[122:123], v7 offset:9184
    s_waitcnt lgkmcnt(12)
    v_mfma_f32_16x16x32_bf16 v[16:19], v[92:95], v[88:91], v[16:19]
    ds_read_b128 v[84:87], v6 offset:384
    ds_read_b64_tr_b16 v[80:81], v7 offset:10752
    ds_read_b64_tr_b16 v[82:83], v7 offset:10976
    s_waitcnt lgkmcnt(12)
    v_mfma_f32_16x16x32_bf16 v[16:19], v[100:103], v[96:99], v[16:19]
    ds_read_b128 v[92:95], v6 offset:448
    ds_read_b64_tr_b16 v[88:89], v7 offset:12544
    ds_read_b64_tr_b16 v[90:91], v7 offset:12768
    s_waitcnt lgkmcnt(12)
    v_mfma_f32_16x16x32_bf16 v[16:19], v[108:111], v[104:107], v[16:19]
    ds_read_b128 v[100:103], v6 offset:512
    ds_read_b64_tr_b16 v[96:97], v7 offset:14336
    ds_read_b64_tr_b16 v[98:99], v7 offset:14560
    s_waitcnt lgkmcnt(12)
    v_mfma_f32_16x16x32_bf16 v[16:19], v[116:119], v[112:115], v[16:19]
    ds_read_b128 v[108:111], v6 offset:576
    ds_read_b64_tr_b16 v[104:105], v7 offset:16128
    ds_read_b64_tr_b16 v[106:107], v7 offset:16352
    s_waitcnt lgkmcnt(12)
    v_mfma_f32_16x16x32_bf16 v[16:19], v[124:127], v[120:123], v[16:19]
    ds_read_b128 v[116:119], v6 offset:640
    ds_read_b64_tr_b16 v[112:113], v7 offset:17920
    ds_read_b64_tr_b16 v[114:115], v7 offset:18144
    s_waitcnt lgkmcnt(12)
    v_mfma_f32_16x16x32_bf16 v[16:19], v[84:87], v[80:83], v[16:19]
    ds_read_b128 v[124:127], v6 offset:704
    ds_read_b64_tr_b16 v[120:121], v7 offset:19712
    ds_read_b64_tr_b16 v[122:123], v7 offset:19936
    s_waitcnt lgkmcnt(12)
    v_mfma_f32_16x16x32_bf16 v[16:19], v[92:95], v[88:91], v[16:19]
    ds_read_b128 v[84:87], v6 offset:768
    ds_read_b64_tr_b16 v[80:81], v7 offset:21504
    ds_read_b64_tr_b16 v[82:83], v7 offset:21728
    s_waitcnt lgkmcnt(12)
    v_mfma_f32_16x16x32_bf16 v[16:19], v[100:103], v[96:99], v[16:19]
    ds_read_b128 v[92:95], v6 offset:832
    ds_read_b64_tr_b16 v[88:89], v7 offset:23296
    ds_read_b64_tr_b16 v[90:91], v7 offset:23520
    s_waitcnt lgkmcnt(12)
    v_mfma_f32_16x16x32_bf16 v[16:19], v[108:111], v[104:107], v[16:19]
    s_waitcnt lgkmcnt(9)
    v_mfma_f32_16x16x32_bf16 v[16:19], v[116:119], v[112:115], v[16:19]
    s_waitcnt lgkmcnt(6)
    v_mfma_f32_16x16x32_bf16 v[16:19], v[124:127], v[120:123], v[16:19]
    s_waitcnt lgkmcnt(3)
    v_mfma_f32_16x16x32_bf16 v[16:19], v[84:87], v[80:83], v[16:19]
    s_waitcnt lgkmcnt(0)
    v_mfma_f32_16x16x32_bf16 v[16:19], v[92:95], v[88:91], v[16:19]
    s_mov_b64 exec, 1
    ds_add_u32 v3, v4 offset:18452
    s_mov_b64 exec, -1
    v_and_b32 v28, 15, v1
    s_lshl_b32 s65, s3, 4
    v_add_u32 v28, s65, v28
    v_cmp_eq_u32 vcc, 28, v28
    v_mov_b32 v28, 0x3f803f80
    s_nop 0
    v_cvt_pk_bf16_f32 v24, v16, v17
    v_cvt_pk_bf16_f32 v25, v18, v19
    v_cndmask_b32 v24, v24, v28, vcc
    v_cndmask_b32 v25, v25, v28, vcc
    v_mov_b32 v26, v24
    v_mov_b32 v27, v25
    s_nop 1
    v_permlane32_swap_b32 v24, v26
    v_permlane32_swap_b32 v25, v27
    s_nop 0
    v_min_u32 v24, s75, v24
    s_mov_b32 exec_hi, 0
    buffer_store_dwordx4 v[24:27], v9, s[44:47], s68 offen sc1
    s_mov_b32 exec_hi, -1
A_KVFLAG:
    ds_read_b64_tr_b16 v[60:61], v10 offset:0
    ds_read_b64_tr_b16 v[62:63], v10 offset:3648
    ds_read_b64_tr_b16 v[64:65], v10 offset:32
    ds_read_b64_tr_b16 v[66:67], v10 offset:3680
    ds_read_b64_tr_b16 v[68:69], v10 offset:64
    ds_read_b64_tr_b16 v[70:71], v10 offset:3712
    ds_read_b64_tr_b16 v[72:73], v10 offset:96
    ds_read_b64_tr_b16 v[74:75], v10 offset:3744
    s_waitcnt lgkmcnt(4)
    buffer_store_dwordx4 v[60:63], v11, s[44:47], s69 offen sc1
    s_add_i32 s69, s69, 65536
    buffer_store_dwordx4 v[64:67], v11, s[44:47], s69 offen sc1
    s_add_i32 s69, s69, 65536
    s_waitcnt lgkmcnt(0)
    buffer_store_dwordx4 v[68:71], v11, s[44:47], s69 offen sc1
    s_add_i32 s69, s69, 65536
    s_cmp_eq_u32 s3, 1
    s_cbranch_scc1 A_XT3
    buffer_store_dwordx4 v[72:75], v11, s[44:47], s69 offen sc1
A_XT3:
    ds_read_b128 v[80:83], v78 offset:0
    ds_read_b128 v[84:87], v78 offset:32
    ds_read_b128 v[88:91], v78 offset:64
    ds_read_b128 v[92:95], v78 offset:96
    ds_read_b128 v[96:99], v78 offset:128
    ds_read_b128 v[100:103], v78 offset:160
    ds_read_b128 v[104:107], v78 offset:192
    ds_read_b128 v[108:111], v78 offset:224
    ds_read_b128 v[112:115], v78 offset:256
    ds_read_b128 v[116:119], v78 offset:288
    ds_read_b128 v[120:123], v78 offset:320
    ds_read_b128 v[124:127], v78 offset:352
    ds_read_b128 a[64:67], v78 offset:384
    ds_read_b128 a[68:71], v78 offset:416
    ds_read_b128 a[72:75], v78 offset:448
    ds_read_b128 a[76:79], v78 offset:480
    ds_read_b128 a[80:83], v78 offset:512
    ds_read_b128 a[84:87], v78 offset:544
    ds_read_b128 a[88:91], v78 offset:576
    ds_read_b128 a[92:95], v78 offset:608
    ds_read_b128 a[96:99], v78 offset:640
    ds_read_b128 a[100:103], v78 offset:672
    ds_read_b128 a[104:107], v78 offset:704
    ds_read_b128 a[108:111], v78 offset:736
    ds_read_b128 a[112:115], v78 offset:768
    ds_read_b128 a[116:119], v78 offset:800
    ds_read_b128 a[120:123], v78 offset:832
    ds_read_b128 a[124:127], v78 offset:864
    s_mov_b64 exec, 1
    ds_add_u32 v3, v4 offset:18492
    s_mov_b64 exec, -1
    s_mov_b32 s56, s10
    s_mov_b32 s57, s11
    s_mov_b32 s58, 401408
    s_mov_b32 s59, 0x00020000
    v_lshrrev_b32 v26, 4, v1
    v_and_b32 v27, 15, v1
    v_lshlrev_b32 v6, 2, v26
    v_xor_b32 v27, v27, v6
    v_mul_u32_u24 v26, 896, v26
    v_lshl_add_u32 v6, v27, 4, v26
W9:
    ds_read_b32 v5, v3 offset:18452
    s_waitcnt lgkmcnt(0)
    v_readfirstlane_b32 s64, v5
    s_cmp_ge_u32 s64, 2
    s_cbranch_scc1 D10
    s_sub_u32 s61, s61, 1
    s_cbranch_scc1 BAIL
    s_sleep 1
    s_branch W9
D10:
    s_cmp_eq_u32 s3, 0
    s_cbranch_scc1 A_NG0
    v_lshlrev_b32 v9, 11, v1
    v_add_u32 v9, 48128, v9
    s_mov_b32 exec_hi, 0x00ffffff
    ds_write_b16 v9, v12 offset:224
    ds_write_b16_d16_hi v9, v12 offset:416
    ds_write_b16 v9, v13 offset:608
    ds_write_b16_d16_hi v9, v13 offset:800
    ds_write_b16 v9, v14 offset:1248
    ds_write_b16_d16_hi v9, v14 offset:1440
    ds_write_b16 v9, v15 offset:1632
    ds_write_b16_d16_hi v9, v15 offset:1824
    s_mov_b32 exec_hi, -1
    s_mov_b64 exec, 1
    ds_add_u32 v3, v4 offset:18436
    s_mov_b64 exec, -1
A_NG0:
    s_lshl_b32 s66, s3, 10
    s_add_u32 m0, s66, 121856
    s_mul_i32 s65, s3, 3584
    s_mul_i32 s66, s5, 224
    s_add_u32 s65, s65, s66
    s_add_u32 s65, s65, 258048
    s_mov_b32 exec_lo, 0xf3ff3fff
    s_mov_b32 exec_hi, 0xfff3ff3f
    s_mov_b32 s66, 10
A_DL3:
    buffer_load_dwordx4 v6, s[56:59], s65 offen lds
    s_add_u32 m0, m0, 2048
    s_add_u32 s65, s65, 7168
    buffer_load_dwordx4 v6, s[56:59], s65 offen lds
    s_add_u32 m0, m0, 2048
    s_add_u32 s65, s65, 7168
    s_sub_u32 s66, s66, 1
    s_cmp_lg_u32 s66, 0
    s_cbranch_scc1 A_DL3
    s_mov_b64 exec, -1
    s_cmp_eq_u32 s3, 0
    s_cbranch_scc1 A_NG1
    s_waitcnt vmcnt(24)
N11:
    v_readfirstlane_b32 s60, v30
    s_cmp_lg_u32 s60, 0
    s_cbranch_scc1 D12
    s_sub_u32 s61, s61, 1
    s_cbranch_scc1 BAIL
    global_load_dword v30, v3, s[40:41] sc1
    s_waitcnt vmcnt(0)
    s_branch N11
D12:
    s_cmp_ge_u32 s5, 2
    s_cbranch_scc1 A_NG1
W13:
    ds_read_b32 v5, v3 offset:18504
    s_waitcnt lgkmcnt(0)
    v_readfirstlane_b32 s64, v5
    s_cmp_ge_u32 s64, 1
    s_cbranch_scc1 D14
    s_sub_u32 s61, s61, 1
    s_cbranch_scc1 BAIL
    s_sleep 1
    s_branch W13
D14:
    ds_read_b32 v29, v8 offset:18688
    s_waitcnt lgkmcnt(0)
    v_add_f32 v31, v31, v29
    s_nop 1
    v_max_f32_dpp v31, v31, v31 row_ror:1 row_mask:0xf bank_mask:0xf
    s_nop 1
    v_max_f32_dpp v31, v31, v31 row_ror:2 row_mask:0xf bank_mask:0xf
    s_nop 1
    v_max_f32_dpp v31, v31, v31 row_ror:4 row_mask:0xf bank_mask:0xf
    s_nop 1
    v_max_f32_dpp v31, v31, v31 row_ror:8 row_mask:0xf bank_mask:0xf
    s_mov_b64 exec, 1
    buffer_store_dwordx2 v[30:31], v3, s[44:47], s71 offen sc1
    s_mov_b64 exec, -1
A_NG1:
    v_lshrrev_b32 v12, 5, v1
    v_bfe_u32 v13, v1, 2, 2
    v_lshl_add_u32 v10, v12, 3, v13
    v_lshlrev_b32 v10, 8, v10
    v_bfe_u32 v11, v1, 4, 1
    v_lshlrev_b32 v11, 5, v11
    v_and_b32 v16, 3, v1
    v_lshl_add_u32 v11, v16, 3, v11
    s_mul_i32 s65, s3, 56
    v_add_u32 v11, s65, v11
    v_lshlrev_b32 v13, 6, v13
    v_xor_b32 v11, v11, v13
    v_add_u32 v10, v10, v11
    v_add_u32 v7, 48128, v10
    v_add_u32 v8, 113664, v10
    s_lshl_b32 s65, s3, 11
    s_add_u32 s65, s65, 48128
    v_add_u32 v10, s65, v2
    v_lshlrev_b32 v11, 2, v1
    s_lshl_b32 s65, s3, 16
    s_add_u32 s52, s42, s65
    s_addc_u32 s53, s43, 0
    s_mov_b32 s54, 0x10000
    s_mov_b32 s55, 0x00020000
    s_lshr_b32 s80, s2, 3
    s_add_u32 s80, s80, s5
    s_lshl_b32 s80, s80, 13
    s_and_b32 s80, s80, 65535
    s_mov_b32 s81, 0
    s_mov_b32 s82, 0
    s_branch A_QSYNC
A_DMAW:
    s_mov_b32 s56, s10
    s_mov_b32 s57, s11
    s_mov_b32 s58, 401408
    s_mov_b32 s59, 0x00020000
    v_lshrrev_b32 v8, 4, v1
    v_and_b32 v9, 15, v1
    v_lshlrev_b32 v10, 2, v8
    v_xor_b32 v9, v9, v10
    v_mul_u32_u24 v8, 896, v8
    v_lshl_add_u32 v6, v9, 4, v8
    v_accvgpr_write_b32 a0, 0
    v_accvgpr_write_b32 a1, 0
    v_accvgpr_write_b32 a2, 0
    v_accvgpr_write_b32 a3, 0
    v_accvgpr_write_b32 a4, 0
    v_accvgpr_write_b32 a5, 0
    v_accvgpr_write_b32 a6, 0
    v_accvgpr_write_b32 a7, 0
    v_accvgpr_write_b32 a8, 0
    v_accvgpr_write_b32 a9, 0
    v_accvgpr_write_b32 a10, 0
    v_accvgpr_write_b32 a11, 0
    v_accvgpr_write_b32 a12, 0
    v_accvgpr_write_b32 a13, 0
    v_accvgpr_write_b32 a14, 0
    v_accvgpr_write_b32 a15, 0
    v_accvgpr_write_b32 a16, 0
    v_accvgpr_write_b32 a17, 0
    v_accvgpr_write_b32 a18, 0
    v_accvgpr_write_b32 a19, 0
    v_accvgpr_write_b32 a20, 0
    v_accvgpr_write_b32 a21, 0
    v_accvgpr_write_b32 a22, 0
    v_accvgpr_write_b32 a23, 0
    v_accvgpr_write_b32 a24, 0
    v_accvgpr_write_b32 a25, 0
    v_accvgpr_write_b32 a26, 0
    v_accvgpr_write_b32 a27, 0
    v_accvgpr_write_b32 a28, 0
    v_accvgpr_write_b32 a29, 0
    v_accvgpr_write_b32 a30, 0
    v_accvgpr_write_b32 a31, 0
    v_accvgpr_write_b32 a32, 0
    v_accvgpr_write_b32 a33, 0
    v_accvgpr_write_b32 a34, 0
    v_accvgpr_write_b32 a35, 0
    v_accvgpr_write_b32 a36, 0
    v_accvgpr_write_b32 a37, 0
    v_accvgpr_write_b32 a38, 0
    v_accvgpr_write_b32 a39, 0
    v_accvgpr_write_b32 a40, 0
    v_accvgpr_write_b32 a41, 0
    v_accvgpr_write_b32 a42, 0
    v_accvgpr_write_b32 a43, 0
    v_accvgpr_write_b32 a44, 0
    v_accvgpr_write_b32 a45, 0
    v_accvgpr_write_b32 a46, 0
    v_accvgpr_write_b32 a47, 0
    v_accvgpr_write_b32 a48, 0
    v_accvgpr_write_b32 a49, 0
    v_accvgpr_write_b32 a50, 0
    v_accvgpr_write_b32 a51, 0
    v_accvgpr_write_b32 a52, 0
    v_accvgpr_write_b32 a53, 0
    v_accvgpr_write_b32 a54, 0
    v_accvgpr_write_b32 a55, 0
    v_accvgpr_write_b32 a56, 0
    v_accvgpr_write_b32 a57, 0
    v_accvgpr_write_b32 a58, 0
    v_accvgpr_write_b32 a59, 0
    v_accvgpr_write_b32 a60, 0
    v_accvgpr_write_b32 a61, 0
    v_accvgpr_write_b32 a62, 0
    v_accvgpr_write_b32 a63, 0
    v_lshrrev_b32 v12, 5, v1
    v_bfe_u32 v13, v1, 2, 2
    v_lshl_add_u32 v10, v12, 3, v13
    v_lshlrev_b32 v10, 8, v10
    v_bfe_u32 v11, v1, 4, 1
    v_lshlrev_b32 v11, 5, v11
    v_and_b32 v16, 3, v1
    v_lshl_add_u32 v11, v16, 3, v11
    s_mul_i32 s65, s3, 56
    v_add_u32 v11, s65, v11
    v_lshlrev_b32 v13, 6, v13
    v_xor_b32 v11, v11, v13
    v_add_u32 v10, v10, v11
    v_add_u32 v7, 48128, v10
    v_add_u32 v8, 113664, v10
    s_lshl_b32 s65, s3, 11
    s_add_u32 s65, s65, 48128
    v_add_u32 v10, s65, v2
    v_lshlrev_b32 v11, 2, v1
    s_lshl_b32 s65, s3, 16
    s_add_u32 s52, s42, s65
    s_addc_u32 s53, s43, 0
    s_mov_b32 s54, 0x10000
    s_mov_b32 s55, 0x00020000
    s_lshr_b32 s80, s2, 3
    s_add_u32 s80, s80, s5
    s_lshl_b32 s80, s80, 13
    s_and_b32 s80, s80, 65535
    s_mov_b32 s81, 0
    s_mov_b32 s82, 0
    s_sub_u32 s65, s3, 2
    s_lshl_b32 s66, s65, 10
    s_add_u32 m0, s66, 48128
    s_mul_i32 s65, s65, 3584
    s_mul_i32 s66, s5, 224
    s_add_u32 s65, s65, s66
W15:
    ds_read_b32 v5, v3 offset:18440
    s_waitcnt lgkmcnt(0)
    v_readfirstlane_b32 s64, v5
    s_cmp_ge_u32 s64, 2
    s_cbranch_scc1 D16
    s_sub_u32 s61, s61, 1
    s_cbranch_scc1 BAIL
    s_sleep 1
    s_branch W15
D16:
    s_mov_b32 exec_lo, 0xf3ff3fff
    s_mov_b32 exec_hi, 0xfff3ff3f
    s_mov_b32 s66, 18
A_DL2:
    buffer_load_dwordx4 v6, s[56:59], s65 offen lds
    s_add_u32 m0, m0, 2048
    s_add_u32 s65, s65, 7168
    buffer_load_dwordx4 v6, s[56:59], s65 offen lds
    s_add_u32 m0, m0, 2048
    s_add_u32 s65, s65, 7168
    s_sub_u32 s66, s66, 1
    s_cmp_lg_u32 s66, 0
    s_cbranch_scc1 A_DL2
    s_mov_b64 exec, -1
    global_load_dword v30, v3, s[40:41] sc1
W17:
    ds_read_b32 v5, v3 offset:18432
    s_waitcnt lgkmcnt(0)
    v_readfirstlane_b32 s64, v5
    s_cmp_ge_u32 s64, 2
    s_cbranch_scc1 D18
    s_sub_u32 s61, s61, 1
    s_cbranch_scc1 BAIL
    s_sleep 1
    s_branch W17
D18:
    s_mov_b64 exec, -1
    ds_read_b128 v[80:83], v78 offset:0
    ds_read_b128 v[84:87], v78 offset:32
    ds_read_b128 v[88:91], v78 offset:64
    ds_read_b128 v[92:95], v78 offset:96
    ds_read_b128 v[96:99], v78 offset:128
    ds_read_b128 v[100:103], v78 offset:160
    ds_read_b128 v[104:107], v78 offset:192
    ds_read_b128 v[108:111], v78 offset:224
    ds_read_b128 v[112:115], v78 offset:256
    ds_read_b128 v[116:119], v78 offset:288
    ds_read_b128 v[120:123], v78 offset:320
    ds_read_b128 v[124:127], v78 offset:352
    ds_read_b128 a[64:67], v78 offset:384
    ds_read_b128 a[68:71], v78 offset:416
    ds_read_b128 a[72:75], v78 offset:448
    ds_read_b128 a[76:79], v78 offset:480
    ds_read_b128 a[80:83], v78 offset:512
    ds_read_b128 a[84:87], v78 offset:544
    ds_read_b128 a[88:91], v78 offset:576
    ds_read_b128 a[92:95], v78 offset:608
    ds_read_b128 a[96:99], v78 offset:640
    ds_read_b128 a[100:103], v78 offset:672
    ds_read_b128 a[104:107], v78 offset:704
    ds_read_b128 a[108:111], v78 offset:736
    ds_read_b128 a[112:115], v78 offset:768
    ds_read_b128 a[116:119], v78 offset:800
    ds_read_b128 a[120:123], v78 offset:832
    ds_read_b128 a[124:127], v78 offset:864
    s_mov_b64 exec, 1
    ds_add_u32 v3, v4 offset:18492
    s_mov_b64 exec, -1
    s_waitcnt vmcnt(0)
    s_mov_b64 exec, 1
    ds_add_u32 v3, v4 offset:18436
    s_mov_b64 exec, -1
N19:
    v_readfirstlane_b32 s60, v30
    s_cmp_lg_u32 s60, 0
    s_cbranch_scc1 D20
    s_sub_u32 s61, s61, 1
    s_cbranch_scc1 BAIL
    global_load_dword v30, v3, s[40:41] sc1
    s_waitcnt vmcnt(0)
    s_branch N19
D20:
A_QSYNC:
    buffer_load_dword v14, v77, s[44:47], s79 offen sc1
W21:
    ds_read_b32 v5, v3 offset:18436
    s_waitcnt lgkmcnt(0)
    v_readfirstlane_b32 s64, v5
    s_cmp_ge_u32 s64, 3
    s_cbranch_scc1 D22
    s_sub_u32 s61, s61, 1
    s_cbranch_scc1 BAIL
    s_sleep 1
    s_branch W21
D22:
    ds_read_b64_tr_b16 v[16:17], v7 offset:0
    ds_read_b64_tr_b16 v[18:19], v7 offset:1024
    ds_read_b64_tr_b16 v[20:21], v7 offset:4096
    ds_read_b64_tr_b16 v[22:23], v7 offset:5120
    ds_read_b64_tr_b16 v[24:25], v7 offset:8192
    ds_read_b64_tr_b16 v[26:27], v7 offset:9216
    ds_read_b64_tr_b16 v[32:33], v7 offset:12288
    ds_read_b64_tr_b16 v[34:35], v7 offset:13312
    ds_read_b64_tr_b16 v[36:37], v7 offset:16384
    ds_read_b64_tr_b16 v[38:39], v7 offset:17408
    s_mov_b64 exec, 1
    ds_add_u32 v3, v4 offset:18500
    s_mov_b64 exec, -1
    ds_read_b64_tr_b16 v[40:41], v7 offset:20480
    ds_read_b64_tr_b16 v[42:43], v7 offset:21504
    s_waitcnt lgkmcnt(11)
    v_mfma_f32_32x32x16_bf16 v[48:63], v[16:19], v[80:83], 0
    ds_read_b64_tr_b16 v[16:17], v7 offset:24576
    ds_read_b64_tr_b16 v[18:19], v7 offset:25600
    s_waitcnt lgkmcnt(11)
    v_mfma_f32_32x32x16_bf16 v[48:63], v[20:23], v[84:87], v[48:63]
    ds_read_b64_tr_b16 v[20:21], v7 offset:28672
    ds_read_b64_tr_b16 v[22:23], v7 offset:29696
    s_waitcnt lgkmcnt(11)
    v_mfma_f32_32x32x16_bf16 v[48:63], v[24:27], v[88:91], v[48:63]
    ds_read_b64_tr_b16 v[24:25], v7 offset:32768
    ds_read_b64_tr_b16 v[26:27], v7 offset:33792
    s_waitcnt lgkmcnt(11)
    v_mfma_f32_32x32x16_bf16 v[48:63], v[32:35], v[92:95], v[48:63]
    ds_read_b64_tr_b16 v[32:33], v7 offset:36864
    ds_read_b64_tr_b16 v[34:35], v7 offset:37888
    s_waitcnt lgkmcnt(11)
    v_mfma_f32_32x32x16_bf16 v[48:63], v[36:39], v[96:99], v[48:63]
    ds_read_b64_tr_b16 v[36:37], v7 offset:40960
    ds_read_b64_tr_b16 v[38:39], v7 offset:41984
    s_waitcnt lgkmcnt(10)
    v_mfma_f32_32x32x16_bf16 v[48:63], v[40:43], v[100:103], v[48:63]
    ds_read_b64_tr_b16 v[40:41], v7 offset:45056
    ds_read_b64_tr_b16 v[42:43], v7 offset:46080
    s_waitcnt lgkmcnt(10)
    v_mfma_f32_32x32x16_bf16 v[48:63], v[16:19], v[104:107], v[48:63]
    ds_read_b64_tr_b16 v[16:17], v7 offset:49152
    ds_read_b64_tr_b16 v[18:19], v7 offset:50176
    s_waitcnt lgkmcnt(10)
    v_mfma_f32_32x32x16_bf16 v[48:63], v[20:23], v[108:111], v[48:63]
    ds_read_b64_tr_b16 v[20:21], v7 offset:53248
    ds_read_b64_tr_b16 v[22:23], v7 offset:54272
    s_waitcnt lgkmcnt(10)
    v_mfma_f32_32x32x16_bf16 v[48:63], v[24:27], v[112:115], v[48:63]
    ds_read_b64_tr_b16 v[24:25], v7 offset:57344
    ds_read_b64_tr_b16 v[26:27], v7 offset:58368
    s_waitcnt lgkmcnt(10)
    v_mfma_f32_32x32x16_bf16 v[48:63], v[32:35], v[116:119], v[48:63]
    s_cmp_ge_u32 s3, 2
    s_cbranch_scc1 A_NOCB
    s_waitcnt vmcnt(1)
    s_mov_b64 exec, 1
    ds_add_u32 v3, v4 offset:18496
    s_mov_b64 exec, -1
A_NOCB:
    ds_read_b64_tr_b16 v[32:33], v7 offset:61440
    ds_read_b64_tr_b16 v[34:35], v7 offset:62464
    s_waitcnt lgkmcnt(10)
    v_mfma_f32_32x32x16_bf16 v[48:63], v[36:39], v[120:123], v[48:63]
    ds_read_b64 v[44:45], v3 offset:18496
    ds_read_b64_tr_b16 v[36:37], v8 offset:0
    ds_read_b64_tr_b16 v[38:39], v8 offset:1024
    s_waitcnt lgkmcnt(11)
    v_mfma_f32_32x32x16_bf16 v[48:63], v[40:43], v[124:127], v[48:63]
    s_waitcnt vmcnt(0)
    s_cmp_ge_u32 s3, 2
    s_cbranch_scc1 A_NOXF
    s_mov_b64 exec, 1
    buffer_store_dword v30, v3, s[44:47], s83 offen sc1
    s_mov_b64 exec, -1
A_NOXF:
    v_cmp_ne_u32 vcc, s60, v14
    s_cbranch_vccnz A_NOTYET
    s_add_u32 s70, s80, 4096
    buffer_load_dwordx4 v[96:99], v2, s[52:55], s80 offen sc1
    buffer_load_dwordx4 v[100:103], v2, s[52:55], s80 offen offset:1024 sc1
    buffer_load_dwordx4 v[104:107], v2, s[52:55], s80 offen offset:2048 sc1
    buffer_load_dwordx4 v[108:111], v2, s[52:55], s80 offen offset:3072 sc1
    buffer_load_dwordx4 v[112:115], v2, s[52:55], s70 offen sc1
    buffer_load_dwordx4 v[116:119], v2, s[52:55], s70 offen offset:1024 sc1
    s_mov_b32 s81, 1
    s_branch A_YET
A_NOTYET:
    buffer_load_dword v14, v77, s[44:47], s79 offen sc1
A_YET:
    ds_read_b64_tr_b16 v[40:41], v8 offset:4096
    ds_read_b64_tr_b16 v[42:43], v8 offset:5120
    s_waitcnt lgkmcnt(11)
    v_mfma_f32_32x32x16_bf16 v[48:63], v[16:19], a[64:67], v[48:63]
    s_waitcnt lgkmcnt(4)
    v_readfirstlane_b32 s64, v44
    v_readfirstlane_b32 s65, v45
    s_cmp_ge_u32 s64, 2
    s_cbranch_scc1 A_CBOK
W23:
    ds_read_b32 v5, v3 offset:18496
    s_waitcnt lgkmcnt(0)
    v_readfirstlane_b32 s64, v5
    s_cmp_ge_u32 s64, 2
    s_cbranch_scc1 D24
    s_sub_u32 s61, s61, 1
    s_cbranch_scc1 BAIL
    s_sleep 1
    s_branch W23
D24:
A_CBOK:
    s_cmp_ge_u32 s65, 4
    s_cbranch_scc1 A_C3OK
W25:
    ds_read_b32 v5, v3 offset:18500
    s_waitcnt lgkmcnt(0)
    v_readfirstlane_b32 s64, v5
    s_cmp_ge_u32 s64, 4
    s_cbranch_scc1 D26
    s_sub_u32 s61, s61, 1
    s_cbranch_scc1 BAIL
    s_sleep 1
    s_branch W25
D26:
A_C3OK:
    ds_read_b64_tr_b16 v[16:17], v8 offset:8192
    ds_read_b64_tr_b16 v[18:19], v8 offset:9216
    s_waitcnt lgkmcnt(11)
    v_mfma_f32_32x32x16_bf16 v[48:63], v[20:23], a[68:71], v[48:63]
    ds_read_b64_tr_b16 v[20:21], v8 offset:12288
    ds_read_b64_tr_b16 v[22:23], v8 offset:13312
    s_waitcnt lgkmcnt(11)
    v_mfma_f32_32x32x16_bf16 v[48:63], v[24:27], a[72:75], v[48:63]
    v_mov_b32 v88, 0
    v_mov_b32 v89, 0
    ds_read_b64_tr_b16 v[24:25], v8 offset:16384
    ds_read_b64_tr_b16 v[26:27], v8 offset:17408
    s_waitcnt lgkmcnt(11)
    v_mfma_f32_32x32x16_bf16 v[48:63], v[32:35], a[76:79], v[48:63]
    v_mov_b32 v90, 0
    v_mov_b32 v91, 0
    ds_read_b64_tr_b16 v[32:33], v8 offset:20480
    ds_read_b64_tr_b16 v[34:35], v8 offset:21504
    s_waitcnt lgkmcnt(10)
    v_mfma_f32_32x32x16_bf16 v[48:63], v[36:39], a[80:83], v[48:63]
    v_mov_b32 v92, 0
    v_mov_b32 v93, 0
    ds_read_b64_tr_b16 v[36:37], v8 offset:24576
    ds_read_b64_tr_b16 v[38:39], v8 offset:25600
    s_waitcnt lgkmcnt(10)
    v_mfma_f32_32x32x16_bf16 v[48:63], v[40:43], a[84:87], v[48:63]
    v_mov_b32 v94, 0
    v_mov_b32 v95, 0
    ds_read_b64_tr_b16 v[40:41], v8 offset:28672
    ds_read_b64_tr_b16 v[42:43], v8 offset:29696
    s_waitcnt lgkmcnt(10)
    v_mfma_f32_32x32x16_bf16 v[48:63], v[16:19], a[88:91], v[48:63]
    v_mov_b32 v120, 0
    v_mov_b32 v121, 0
    ds_read_b64_tr_b16 v[16:17], v8 offset:32768
    ds_read_b64_tr_b16 v[18:19], v8 offset:33792
    s_waitcnt lgkmcnt(10)
    v_mfma_f32_32x32x16_bf16 v[48:63], v[20:23], a[92:95], v[48:63]
    v_mov_b32 v122, 0
    v_mov_b32 v123, 0
    ds_read_b64_tr_b16 v[20:21], v8 offset:36864
    ds_read_b64_tr_b16 v[22:23], v8 offset:37888
    s_waitcnt lgkmcnt(10)
    v_mfma_f32_32x32x16_bf16 v[48:63], v[24:27], a[96:99], v[48:63]
    v_mov_b32 v124, 0
    v_mov_b32 v125, 0
    ds_read_b64_tr_b16 v[24:25], v8 offset:40960
    ds_read_b64_tr_b16 v[26:27], v8 offset:41984
    s_waitcnt lgkmcnt(10)
    v_mfma_f32_32x32x16_bf16 v[48:63], v[32:35], a[100:103], v[48:63]
    v_mov_b32 v126, 0
    v_mov_b32 v127, 0
    ds_read_b64_tr_b16 v[32:33], v8 offset:45056
    ds_read_b64_tr_b16 v[34:35], v8 offset:46080
    s_waitcnt lgkmcnt(10)
    v_mfma_f32_32x32x16_bf16 v[48:63], v[36:39], a[104:107], v[48:63]
    s_add_u32 s65, s3, 1
    s_and_b32 s65, s65, 3
    s_lshl_b32 s66, s65, 11
    s_add_u32 s66, s66, 48128
    v_add_u32 v72, s66, v2
    s_add_u32 s65, s3, 2
    s_and_b32 s65, s65, 3
    s_lshl_b32 s66, s65, 11
    s_add_u32 s66, s66, 48128
    v_add_u32 v73, s66, v2
    s_waitcnt lgkmcnt(8)
    v_mfma_f32_32x32x16_bf16 v[48:63], v[40:43], a[108:111], v[48:63]
    s_add_u32 s65, s3, 3
    s_and_b32 s65, s65, 3
    s_lshl_b32 s66, s65, 11
    s_add_u32 s66, s66, 48128
    v_add_u32 v74, s66, v2
    v_lshlrev_b32 v15, 2, v1
    s_waitcnt lgkmcnt(6)
    v_mfma_f32_32x32x16_bf16 v[48:63], v[16:19], a[112:115], v[48:63]
    s_waitcnt lgkmcnt(4)
    v_mfma_f32_32x32x16_bf16 v[48:63], v[20:23], a[116:119], v[48:63]
    s_waitcnt lgkmcnt(2)
    v_mfma_f32_32x32x16_bf16 v[48:63], v[24:27], a[120:123], v[48:63]
    s_waitcnt lgkmcnt(0)
    v_mfma_f32_32x32x16_bf16 v[48:63], v[32:35], a[124:127], v[48:63]
    s_sub_u32 s65, s3, 1
    s_and_b32 s65, s65, 3
    s_mul_i32 s65, s65, 12288
    s_add_u32 s66, s65, 48128
    s_sub_u32 s65, s3, 2
    s_and_b32 s65, s65, 3
    s_mul_i32 s65, s65, 12288
    s_add_u32 s67, s65, 52224
    s_sub_u32 s65, s3, 3
    s_and_b32 s65, s65, 3
    s_mul_i32 s65, s65, 12288
    s_add_u32 s68, s65, 56320
    v_cvt_pk_bf16_f32 v40, v48, v49
    v_cvt_pk_bf16_f32 v41, v50, v51
    v_cvt_pk_bf16_f32 v42, v52, v53
    v_cvt_pk_bf16_f32 v43, v54, v55
    v_cvt_pk_bf16_f32 v44, v56, v57
    v_cvt_pk_bf16_f32 v45, v58, v59
    v_cvt_pk_bf16_f32 v46, v60, v61
    v_cvt_pk_bf16_f32 v47, v62, v63
    v_cndmask_b32 v46, v46, 0, s[62:63]
    v_cndmask_b32 v47, v47, 0, s[62:63]
    ds_write_b128 v10, v[40:43]
    ds_write_b128 v10, v[44:47] offset:1024
    s_mov_b64 exec, 1
    ds_add_u32 v3, v4 offset:18444
    s_mov_b64 exec, -1
    s_cmp_lg_u32 s3, 3
    s_cbranch_scc1 A_NOG
    v_mul_f32 v6, 3216550459, v60
    v_exp_f32 v6, v6
    s_nop 0
    v_add_f32 v6, 1.0, v6
    v_rcp_f32 v6, v6
    s_mov_b32 exec_lo, 0
    ds_write_b32 v11, v6 offset:18432
    ds_write_b32 v11, v6 offset:18560
    s_mov_b32 exec_lo, -1
A_NOG:
W27:
    ds_read_b32 v5, v3 offset:18444
    s_waitcnt lgkmcnt(0)
    v_readfirstlane_b32 s64, v5
    s_cmp_ge_u32 s64, 4
    s_cbranch_scc1 D28
    s_sub_u32 s61, s61, 1
    s_cbranch_scc1 BAIL
    s_branch W27
D28:
    ds_read_b128 v[16:19], v72
    ds_read_b128 v[20:23], v72 offset:1024
    ds_read_b128 v[24:27], v73
    ds_read_b128 v[28:31], v73 offset:1024
    ds_read_b128 v[32:35], v74
    ds_read_b128 v[36:39], v74 offset:1024
    v_mov_b32 v6, 0
    v_dot2c_f32_bf16 v6, v40, v40
    v_dot2c_f32_bf16 v6, v41, v41
    v_dot2c_f32_bf16 v6, v42, v42
    v_dot2c_f32_bf16 v6, v43, v43
    v_dot2c_f32_bf16 v6, v44, v44
    v_dot2c_f32_bf16 v6, v45, v45
    v_dot2c_f32_bf16 v6, v46, v46
    v_dot2c_f32_bf16 v6, v47, v47
    v_add_u32 v12, s66, v2
    v_add_u32 v13, s67, v2
    s_nop 0
    v_mov_b32 v7, v6
    s_nop 1
    v_permlane32_swap_b32 v6, v7
    s_nop 1
    v_add_f32 v6, v6, v7
    s_mov_b32 exec_hi, 0
    ds_max_u32 v3, v6 offset:18528
    s_mov_b32 exec_hi, -1
    s_cmp_lg_u32 s81, 0
    s_cbranch_scc1 A_GOT
A_POLL:
    s_waitcnt vmcnt(0)
    v_cmp_ne_u32 vcc, s60, v14
    s_cbranch_vccz A_GOT0
    s_sub_u32 s61, s61, 1
    s_cbranch_scc1 BAIL
    buffer_load_dword v14, v77, s[44:47], s79 offen sc1
    s_branch A_POLL
A_GOT0:
    s_add_u32 s70, s80, 4096
    buffer_load_dwordx4 v[96:99], v2, s[52:55], s80 offen sc1
    buffer_load_dwordx4 v[100:103], v2, s[52:55], s80 offen offset:1024 sc1
    buffer_load_dwordx4 v[104:107], v2, s[52:55], s80 offen offset:2048 sc1
    buffer_load_dwordx4 v[108:111], v2, s[52:55], s80 offen offset:3072 sc1
    buffer_load_dwordx4 v[112:115], v2, s[52:55], s70 offen sc1
    buffer_load_dwordx4 v[116:119], v2, s[52:55], s70 offen offset:1024 sc1
A_GOT:
    s_mov_b64 exec, 1
    ds_add_u32 v3, v4 offset:18448
    s_mov_b64 exec, -1
    s_mul_i32 s65, s3, 12288
    s_add_u32 s65, s65, 48128
    v_add_u32 v6, s65, v2
    v_add_u32 v14, s68, v2
    s_waitcnt lgkmcnt(6)
    s_waitcnt vmcnt(2)
A_MAIN:
    s_setprio 1
    v_cmp_u_f32 vcc, v96, v100
    s_nop 0
    s_cbranch_vccnz A_RL0
A_RB0:
    v_mfma_f32_32x32x16_bf16 v[48:63], v[96:99], v[16:19], 0
    v_mfma_f32_32x32x16_bf16 v[48:63], v[100:103], v[20:23], v[48:63]
    v_mov_b32 v78, 0
    v_mov_b32 v79, 0
    s_mov_b32 s73, 7
    s_mov_b32 s71, 0x07060302
    s_mov_b32 s72, 1170735104
    s_nop 3
    s_waitcnt lgkmcnt(0)
.p2align 6
A_LOOP:
    v_mfma_f32_32x32x16_bf16 a[48:63], v[120:123], v[88:91], a[48:63]
    v_perm_b32 v95, v79, v78, s71
    v_exp_f32 v48, v48
    v_exp_f32 v49, v49
    v_exp_f32 v50, v50
    v_exp_f32 v51, v51
    v_mfma_f32_32x32x16_bf16 v[64:79], v[96:99], v[24:27], 0
    v_perm_b32 v80, v49, v48, s71
    v_exp_f32 v52, v52
    v_exp_f32 v53, v53
    v_perm_b32 v81, v51, v50, s71
    v_exp_f32 v54, v54
    v_exp_f32 v55, v55
    v_mfma_f32_32x32x16_bf16 v[64:79], v[100:103], v[28:31], v[64:79]
    v_perm_b32 v82, v53, v52, s71
    v_exp_f32 v56, v56
    v_exp_f32 v57, v57
    v_perm_b32 v83, v55, v54, s71
    v_exp_f32 v58, v58
    v_exp_f32 v59, v59
    v_perm_b32 v84, v57, v56, s71
    v_mfma_f32_32x32x16_bf16 a[48:63], v[124:127], v[92:95], a[48:63]
    s_waitcnt vmcnt(2)
    v_cmp_u_f32 vcc, v104, v108
    v_exp_f32 v60, v60
    v_exp_f32 v61, v61
    v_perm_b32 v85, v59, v58, s71
    v_exp_f32 v62, v62
    v_exp_f32 v63, v63
    v_perm_b32 v86, v61, v60, s71
    s_cbranch_vccnz A_RL1
A_RB1:
    v_mfma_f32_32x32x16_bf16 a[0:15], v[104:107], v[80:83], a[0:15]
    v_perm_b32 v87, v63, v62, s71
    v_exp_f32 v64, v64
    v_exp_f32 v65, v65
    v_exp_f32 v66, v66
    v_exp_f32 v67, v67
    v_mfma_f32_32x32x16_bf16 v[48:63], v[96:99], v[32:35], 0
    buffer_load_dwordx4 v[120:123], v2, s[52:55], s70 offen offset:2048 sc1
    v_perm_b32 v88, v65, v64, s71
    v_exp_f32 v68, v68
    v_exp_f32 v69, v69
    v_perm_b32 v89, v67, v66, s71
    v_exp_f32 v70, v70
    v_exp_f32 v71, v71
    v_mfma_f32_32x32x16_bf16 v[48:63], v[100:103], v[36:39], v[48:63]
    buffer_load_dwordx4 v[124:127], v2, s[52:55], s70 offen offset:3072 sc1
    v_perm_b32 v90, v69, v68, s71
    v_exp_f32 v72, v72
    v_exp_f32 v73, v73
    v_perm_b32 v91, v71, v70, s71
    v_exp_f32 v74, v74
    v_exp_f32 v75, v75
    v_perm_b32 v92, v73, v72, s71
    v_mfma_f32_32x32x16_bf16 a[0:15], v[108:111], v[84:87], a[0:15]
    s_add_u32 s70, s70, 4096
    s_and_b32 s70, s70, 0xffff
    v_exp_f32 v76, v76
    v_exp_f32 v77, v77
    v_perm_b32 v93, v75, v74, s71
    v_exp_f32 v78, v78
    v_exp_f32 v79, v79
    v_perm_b32 v94, v77, v76, s71
    v_mfma_f32_32x32x16_bf16 a[16:31], v[104:107], v[88:91], a[16:31]
    v_perm_b32 v95, v79, v78, s71
    v_exp_f32 v48, v48
    v_exp_f32 v49, v49
    v_exp_f32 v50, v50
    v_exp_f32 v51, v51
    v_mfma_f32_32x32x16_bf16 v[64:79], v[96:99], v[40:43], 0
    v_perm_b32 v80, v49, v48, s71
    v_exp_f32 v52, v52
    v_exp_f32 v53, v53
    v_perm_b32 v81, v51, v50, s71
    v_exp_f32 v54, v54
    v_exp_f32 v55, v55
    v_mfma_f32_32x32x16_bf16 v[64:79], v[100:103], v[44:47], v[64:79]
    v_perm_b32 v82, v53, v52, s71
    v_exp_f32 v56, v56
    v_exp_f32 v57, v57
    v_perm_b32 v83, v55, v54, s71
    v_exp_f32 v58, v58
    v_exp_f32 v59, v59
    v_perm_b32 v84, v57, v56, s71
    v_mfma_f32_32x32x16_bf16 a[16:31], v[108:111], v[92:95], a[16:31]
    v_exp_f32 v60, v60
    v_exp_f32 v61, v61
    v_perm_b32 v85, v59, v58, s71
    v_exp_f32 v62, v62
    v_exp_f32 v63, v63
    v_perm_b32 v86, v61, v60, s71
    v_mfma_f32_32x32x16_bf16 a[32:47], v[104:107], v[80:83], a[32:47]
    s_waitcnt vmcnt(2)
    v_cmp_u_f32 vcc, v112, v116
    v_perm_b32 v87, v63, v62, s71
    v_exp_f32 v64, v64
    v_exp_f32 v65, v65
    v_exp_f32 v66, v66
    v_exp_f32 v67, v67
    s_cbranch_vccnz A_RL2
A_RB2:
    v_mfma_f32_32x32x16_bf16 v[48:63], v[112:115], v[16:19], 0
    v_perm_b32 v88, v65, v64, s71
    v_exp_f32 v68, v68
    v_exp_f32 v69, v69
    v_perm_b32 v89, v67, v66, s71
    v_exp_f32 v70, v70
    v_exp_f32 v71, v71
    v_mfma_f32_32x32x16_bf16 v[48:63], v[116:119], v[20:23], v[48:63]
    buffer_load_dwordx4 v[96:99], v2, s[52:55], s70 offen offset:0 sc1
    v_perm_b32 v90, v69, v68, s71
    v_exp_f32 v72, v72
    v_exp_f32 v73, v73
    v_perm_b32 v91, v71, v70, s71
    v_exp_f32 v74, v74
    v_exp_f32 v75, v75
    v_perm_b32 v92, v73, v72, s71
    v_mfma_f32_32x32x16_bf16 a[32:47], v[108:111], v[84:87], a[32:47]
    buffer_load_dwordx4 v[100:103], v2, s[52:55], s70 offen offset:1024 sc1
    v_exp_f32 v76, v76
    v_exp_f32 v77, v77
    v_perm_b32 v93, v75, v74, s71
    v_exp_f32 v78, v78
    v_exp_f32 v79, v79
    v_perm_b32 v94, v77, v76, s71
    v_mfma_f32_32x32x16_bf16 a[48:63], v[104:107], v[88:91], a[48:63]
    v_perm_b32 v95, v79, v78, s71
    v_exp_f32 v48, v48
    v_exp_f32 v49, v49
    v_exp_f32 v50, v50
    v_exp_f32 v51, v51
    v_mfma_f32_32x32x16_bf16 v[64:79], v[112:115], v[24:27], 0
    v_perm_b32 v80, v49, v48, s71
    v_exp_f32 v52, v52
    v_exp_f32 v53, v53
    v_perm_b32 v81, v51, v50, s71
    v_exp_f32 v54, v54
    v_exp_f32 v55, v55
    v_mfma_f32_32x32x16_bf16 v[64:79], v[116:119], v[28:31], v[64:79]
    v_perm_b32 v82, v53, v52, s71
    v_exp_f32 v56, v56
    v_exp_f32 v57, v57
    v_perm_b32 v83, v55, v54, s71
    v_exp_f32 v58, v58
    v_exp_f32 v59, v59
    v_perm_b32 v84, v57, v56, s71
    v_mfma_f32_32x32x16_bf16 a[48:63], v[108:111], v[92:95], a[48:63]
    s_waitcnt vmcnt(2)
    v_cmp_u_f32 vcc, v120, v124
    v_exp_f32 v60, v60
    v_exp_f32 v61, v61
    v_perm_b32 v85, v59, v58, s71
    v_exp_f32 v62, v62
    v_exp_f32 v63, v63
    v_perm_b32 v86, v61, v60, s71
    s_cbranch_vccnz A_RL3
A_RB3:
    v_mfma_f32_32x32x16_bf16 a[0:15], v[120:123], v[80:83], a[0:15]
    v_perm_b32 v87, v63, v62, s71
    v_exp_f32 v64, v64
    v_exp_f32 v65, v65
    v_exp_f32 v66, v66
    v_exp_f32 v67, v67
    v_mfma_f32_32x32x16_bf16 v[48:63], v[112:115], v[32:35], 0
    buffer_load_dwordx4 v[104:107], v2, s[52:55], s70 offen offset:2048 sc1
    v_perm_b32 v88, v65, v64, s71
    v_exp_f32 v68, v68
    v_exp_f32 v69, v69
    v_perm_b32 v89, v67, v66, s71
    v_exp_f32 v70, v70
    v_exp_f32 v71, v71
    v_mfma_f32_32x32x16_bf16 v[48:63], v[116:119], v[36:39], v[48:63]
    buffer_load_dwordx4 v[108:111], v2, s[52:55], s70 offen offset:3072 sc1
    v_perm_b32 v90, v69, v68, s71
    v_exp_f32 v72, v72
    v_exp_f32 v73, v73
    v_perm_b32 v91, v71, v70, s71
    v_exp_f32 v74, v74
    v_exp_f32 v75, v75
    v_perm_b32 v92, v73, v72, s71
    v_mfma_f32_32x32x16_bf16 a[0:15], v[124:127], v[84:87], a[0:15]
    s_add_u32 s70, s70, 4096
    v_exp_f32 v76, v76
    v_exp_f32 v77, v77
    v_perm_b32 v93, v75, v74, s71
    v_exp_f32 v78, v78
    v_exp_f32 v79, v79
    v_perm_b32 v94, v77, v76, s71
    v_mfma_f32_32x32x16_bf16 a[16:31], v[120:123], v[88:91], a[16:31]
    v_perm_b32 v95, v79, v78, s71
    v_exp_f32 v48, v48
    v_exp_f32 v49, v49
    v_exp_f32 v50, v50
    v_exp_f32 v51, v51
    v_mfma_f32_32x32x16_bf16 v[64:79], v[112:115], v[40:43], 0
    v_perm_b32 v80, v49, v48, s71
    v_exp_f32 v52, v52
    v_exp_f32 v53, v53
    v_perm_b32 v81, v51, v50, s71
    v_exp_f32 v54, v54
    v_exp_f32 v55, v55
    v_mfma_f32_32x32x16_bf16 v[64:79], v[116:119], v[44:47], v[64:79]
    v_perm_b32 v82, v53, v52, s71
    v_exp_f32 v56, v56
    v_exp_f32 v57, v57
    v_perm_b32 v83, v55, v54, s71
    v_exp_f32 v58, v58
    v_exp_f32 v59, v59
    v_perm_b32 v84, v57, v56, s71
    v_mfma_f32_32x32x16_bf16 a[16:31], v[124:127], v[92:95], a[16:31]
    v_exp_f32 v60, v60
    v_exp_f32 v61, v61
    v_perm_b32 v85, v59, v58, s71
    v_exp_f32 v62, v62
    v_exp_f32 v63, v63
    v_perm_b32 v86, v61, v60, s71
    v_mfma_f32_32x32x16_bf16 a[32:47], v[120:123], v[80:83], a[32:47]
    s_waitcnt vmcnt(2)
    v_cmp_u_f32 vcc, v96, v100
    v_perm_b32 v87, v63, v62, s71
    v_exp_f32 v64, v64
    v_exp_f32 v65, v65
    v_exp_f32 v66, v66
    v_exp_f32 v67, v67
    s_cbranch_vccnz A_RL4
A_RB4:
    v_mfma_f32_32x32x16_bf16 v[48:63], v[96:99], v[16:19], 0
    v_perm_b32 v88, v65, v64, s71
    v_exp_f32 v68, v68
    v_exp_f32 v69, v69
    v_perm_b32 v89, v67, v66, s71
    v_exp_f32 v70, v70
    v_exp_f32 v71, v71
    v_mfma_f32_32x32x16_bf16 v[48:63], v[100:103], v[20:23], v[48:63]
    buffer_load_dwordx4 v[112:115], v2, s[52:55], s70 offen offset:0 sc1
    s_sub_u32 s73, s73, 1
    v_perm_b32 v90, v69, v68, s71
    v_exp_f32 v72, v72
    v_exp_f32 v73, v73
    v_perm_b32 v91, v71, v70, s71
    v_exp_f32 v74, v74
    v_exp_f32 v75, v75
    v_perm_b32 v92, v73, v72, s71
    v_mfma_f32_32x32x16_bf16 a[32:47], v[124:127], v[84:87], a[32:47]
    buffer_load_dwordx4 v[116:119], v2, s[52:55], s70 offen offset:1024 sc1
    s_cmp_lg_u32 s73, 0
    v_exp_f32 v76, v76
    v_exp_f32 v77, v77
    v_perm_b32 v93, v75, v74, s71
    v_exp_f32 v78, v78
    v_exp_f32 v79, v79
    v_perm_b32 v94, v77, v76, s71
    s_cbranch_scc1 A_LOOP
    v_mfma_f32_32x32x16_bf16 a[48:63], v[120:123], v[88:91], a[48:63]
    v_perm_b32 v95, v79, v78, s71
    v_exp_f32 v48, v48
    v_exp_f32 v49, v49
    v_exp_f32 v50, v50
    v_exp_f32 v51, v51
    v_mfma_f32_32x32x16_bf16 v[64:79], v[96:99], v[24:27], 0
    ds_read_b32 v5, v3 offset:18484
    v_perm_b32 v80, v49, v48, s71
    v_exp_f32 v52, v52
    v_exp_f32 v53, v53
    v_perm_b32 v81, v51, v50, s71
    v_exp_f32 v54, v54
    v_exp_f32 v55, v55
    v_mfma_f32_32x32x16_bf16 v[64:79], v[100:103], v[28:31], v[64:79]
    v_perm_b32 v82, v53, v52, s71
    v_exp_f32 v56, v56
    v_exp_f32 v57, v57
    v_perm_b32 v83, v55, v54, s71
    v_exp_f32 v58, v58
    v_exp_f32 v59, v59
    v_perm_b32 v84, v57, v56, s71
    v_mfma_f32_32x32x16_bf16 a[48:63], v[124:127], v[92:95], a[48:63]
    s_waitcnt vmcnt(2)
    v_cmp_u_f32 vcc, v104, v108
    v_exp_f32 v60, v60
    v_exp_f32 v61, v61
    v_perm_b32 v85, v59, v58, s71
    v_exp_f32 v62, v62
    v_exp_f32 v63, v63
    v_perm_b32 v86, v61, v60, s71
    s_cbranch_vccnz A_RL5
A_RB5:
    v_mfma_f32_32x32x16_bf16 a[0:15], v[104:107], v[80:83], a[0:15]
    v_perm_b32 v87, v63, v62, s71
    v_exp_f32 v64, v64
    v_exp_f32 v65, v65
    v_exp_f32 v66, v66
    v_exp_f32 v67, v67
    v_mfma_f32_32x32x16_bf16 v[48:63], v[96:99], v[32:35], 0
    buffer_load_dwordx4 v[120:123], v2, s[52:55], s70 offen offset:2048 sc1
    v_perm_b32 v88, v65, v64, s71
    v_exp_f32 v68, v68
    v_exp_f32 v69, v69
    v_perm_b32 v89, v67, v66, s71
    v_exp_f32 v70, v70
    v_exp_f32 v71, v71
    v_mfma_f32_32x32x16_bf16 v[48:63], v[100:103], v[36:39], v[48:63]
    buffer_load_dwordx4 v[124:127], v2, s[52:55], s70 offen offset:3072 sc1
    v_perm_b32 v90, v69, v68, s71
    v_exp_f32 v72, v72
    v_exp_f32 v73, v73
    v_perm_b32 v91, v71, v70, s71
    v_exp_f32 v74, v74
    v_exp_f32 v75, v75
    v_perm_b32 v92, v73, v72, s71
    v_mfma_f32_32x32x16_bf16 a[0:15], v[108:111], v[84:87], a[0:15]
    s_add_u32 s70, s70, 4096
    s_and_b32 s70, s70, 0xffff
    v_exp_f32 v76, v76
    v_exp_f32 v77, v77
    v_perm_b32 v93, v75, v74, s71
    v_exp_f32 v78, v78
    v_exp_f32 v79, v79
    v_perm_b32 v94, v77, v76, s71
    v_mfma_f32_32x32x16_bf16 a[16:31], v[104:107], v[88:91], a[16:31]
    s_waitcnt lgkmcnt(0)
    v_perm_b32 v95, v79, v78, s71
    v_exp_f32 v48, v48
    v_exp_f32 v49, v49
    v_exp_f32 v50, v50
    v_exp_f32 v51, v51
    v_mfma_f32_32x32x16_bf16 v[64:79], v[96:99], v[40:43], 0
    v_readfirstlane_b32 s64, v5
    v_perm_b32 v80, v49, v48, s71
    v_exp_f32 v52, v52
    v_exp_f32 v53, v53
    v_perm_b32 v81, v51, v50, s71
    v_exp_f32 v54, v54
    v_exp_f32 v55, v55
    v_mfma_f32_32x32x16_bf16 v[64:79], v[100:103], v[44:47], v[64:79]
    s_cmp_ge_u32 s64, 4
    s_cbranch_scc0 A_C7WAIT
A_C7OK:
    ds_read_b64 v[96:97], v3 offset:18528
    v_perm_b32 v82, v53, v52, s71
    v_exp_f32 v56, v56
    v_exp_f32 v57, v57
    v_perm_b32 v83, v55, v54, s71
    v_exp_f32 v58, v58
    v_exp_f32 v59, v59
    v_perm_b32 v84, v57, v56, s71
    v_mfma_f32_32x32x16_bf16 a[16:31], v[108:111], v[92:95], a[16:31]
    ds_read_b32 v98, v15 offset:18560
    v_exp_f32 v60, v60
    v_exp_f32 v61, v61
    v_perm_b32 v85, v59, v58, s71
    v_exp_f32 v62, v62
    v_exp_f32 v63, v63
    v_perm_b32 v86, v61, v60, s71
    v_mfma_f32_32x32x16_bf16 a[32:47], v[104:107], v[80:83], a[32:47]
    s_waitcnt vmcnt(2)
    v_cmp_u_f32 vcc, v112, v116
    v_perm_b32 v87, v63, v62, s71
    v_exp_f32 v64, v64
    v_exp_f32 v65, v65
    v_exp_f32 v66, v66
    v_exp_f32 v67, v67
    s_cbranch_vccnz A_RL6
A_RB6:
    v_mfma_f32_32x32x16_bf16 v[48:63], v[112:115], v[16:19], 0
    v_perm_b32 v88, v65, v64, s71
    v_exp_f32 v68, v68
    v_exp_f32 v69, v69
    v_perm_b32 v89, v67, v66, s71
    v_exp_f32 v70, v70
    v_exp_f32 v71, v71
    v_mfma_f32_32x32x16_bf16 v[48:63], v[116:119], v[20:23], v[48:63]
    v_perm_b32 v90, v69, v68, s71
    v_exp_f32 v72, v72
    v_exp_f32 v73, v73
    v_perm_b32 v91, v71, v70, s71
    v_exp_f32 v74, v74
    v_exp_f32 v75, v75
    v_perm_b32 v92, v73, v72, s71
    v_mfma_f32_32x32x16_bf16 a[32:47], v[108:111], v[84:87], a[32:47]
    v_exp_f32 v76, v76
    v_exp_f32 v77, v77
    v_perm_b32 v93, v75, v74, s71
    v_exp_f32 v78, v78
    v_exp_f32 v79, v79
    v_perm_b32 v94, v77, v76, s71
    v_mfma_f32_32x32x16_bf16 a[48:63], v[104:107], v[88:91], a[48:63]
    v_perm_b32 v95, v79, v78, s71
    v_exp_f32 v48, v48
    v_exp_f32 v49, v49
    v_exp_f32 v50, v50
    v_exp_f32 v51, v51
    v_mfma_f32_32x32x16_bf16 v[64:79], v[112:115], v[24:27], 0
    v_perm_b32 v80, v49, v48, s71
    v_exp_f32 v52, v52
    v_exp_f32 v53, v53
    v_perm_b32 v81, v51, v50, s71
    v_exp_f32 v54, v54
    v_exp_f32 v55, v55
    v_mfma_f32_32x32x16_bf16 v[64:79], v[116:119], v[28:31], v[64:79]
    s_waitcnt lgkmcnt(0)
    v_mul_f32 v96, v96, v97
    v_perm_b32 v82, v53, v52, s71
    v_exp_f32 v56, v56
    v_exp_f32 v57, v57
    v_perm_b32 v83, v55, v54, s71
    v_exp_f32 v58, v58
    v_exp_f32 v59, v59
    v_perm_b32 v84, v57, v56, s71
    v_mfma_f32_32x32x16_bf16 a[48:63], v[108:111], v[92:95], a[48:63]
    v_cmp_nle_f32 s[76:77], v96, s72
    s_waitcnt vmcnt(0)
    v_cmp_u_f32 vcc, v120, v124
    v_exp_f32 v60, v60
    v_exp_f32 v61, v61
    v_perm_b32 v85, v59, v58, s71
    v_exp_f32 v62, v62
    v_exp_f32 v63, v63
    v_perm_b32 v86, v61, v60, s71
    s_cbranch_vccnz A_RL7
A_RB7:
    v_mfma_f32_32x32x16_bf16 a[0:15], v[120:123], v[80:83], a[0:15]
    s_cmp_lg_u64 s[76:77], 0
    s_cbranch_scc1 A_UNSAFE
A_SAFE:
    v_perm_b32 v87, v63, v62, s71
    v_exp_f32 v64, v64
    v_exp_f32 v65, v65
    v_exp_f32 v66, v66
    v_exp_f32 v67, v67
    v_mfma_f32_32x32x16_bf16 v[48:63], v[112:115], v[32:35], 0
    v_perm_b32 v88, v65, v64, s71
    v_exp_f32 v68, v68
    v_exp_f32 v69, v69
    v_perm_b32 v89, v67, v66, s71
    v_exp_f32 v70, v70
    v_exp_f32 v71, v71
    v_mfma_f32_32x32x16_bf16 v[48:63], v[116:119], v[36:39], v[48:63]
    v_perm_b32 v90, v69, v68, s71
    v_exp_f32 v72, v72
    v_exp_f32 v73, v73
    v_perm_b32 v91, v71, v70, s71
    v_exp_f32 v74, v74
    v_exp_f32 v75, v75
    v_perm_b32 v92, v73, v72, s71
    v_mfma_f32_32x32x16_bf16 a[0:15], v[124:127], v[84:87], a[0:15]
    v_exp_f32 v76, v76
    v_exp_f32 v77, v77
    v_perm_b32 v93, v75, v74, s71
    v_exp_f32 v78, v78
    v_exp_f32 v79, v79
    v_perm_b32 v94, v77, v76, s71
    v_mfma_f32_32x32x16_bf16 a[16:31], v[120:123], v[88:91], a[16:31]
    v_perm_b32 v95, v79, v78, s71
    v_exp_f32 v48, v48
    v_exp_f32 v49, v49
    v_exp_f32 v50, v50
    v_exp_f32 v51, v51
    v_mfma_f32_32x32x16_bf16 v[64:79], v[112:115], v[40:43], 0
    ds_write_b128 v6, a[0:3] offset:0
    v_perm_b32 v80, v49, v48, s71
    v_exp_f32 v52, v52
    v_exp_f32 v53, v53
    v_perm_b32 v81, v51, v50, s71
    v_exp_f32 v54, v54
    v_exp_f32 v55, v55
    v_mfma_f32_32x32x16_bf16 v[64:79], v[116:119], v[44:47], v[64:79]
    ds_write_b128 v6, a[4:7] offset:1024
    v_perm_b32 v82, v53, v52, s71
    v_exp_f32 v56, v56
    v_exp_f32 v57, v57
    v_perm_b32 v83, v55, v54, s71
    v_exp_f32 v58, v58
    v_exp_f32 v59, v59
    v_perm_b32 v84, v57, v56, s71
    v_mfma_f32_32x32x16_bf16 a[16:31], v[124:127], v[92:95], a[16:31]
    ds_write_b128 v6, a[8:11] offset:2048
    ds_write_b128 v6, a[12:15] offset:3072
    v_exp_f32 v60, v60
    v_exp_f32 v61, v61
    v_perm_b32 v85, v59, v58, s71
    v_exp_f32 v62, v62
    v_exp_f32 v63, v63
    v_perm_b32 v86, v61, v60, s71
    v_mfma_f32_32x32x16_bf16 a[32:47], v[120:123], v[80:83], a[32:47]
    v_perm_b32 v87, v63, v62, s71
    v_exp_f32 v64, v64
    v_exp_f32 v65, v65
    v_exp_f32 v66, v66
    v_exp_f32 v67, v67
    ds_write_b128 v6, a[16:19] offset:4096
    v_perm_b32 v88, v65, v64, s71
    v_exp_f32 v68, v68
    v_exp_f32 v69, v69
    v_perm_b32 v89, v67, v66, s71
    v_exp_f32 v70, v70
    v_exp_f32 v71, v71
    ds_write_b128 v6, a[20:23] offset:5120
    v_perm_b32 v90, v69, v68, s71
    v_exp_f32 v72, v72
    v_exp_f32 v73, v73
    v_perm_b32 v91, v71, v70, s71
    v_exp_f32 v74, v74
    v_exp_f32 v75, v75
    v_perm_b32 v92, v73, v72, s71
    v_mfma_f32_32x32x16_bf16 a[32:47], v[124:127], v[84:87], a[32:47]
    ds_write_b128 v6, a[24:27] offset:6144
    ds_write_b128 v6, a[28:31] offset:7168
    v_exp_f32 v76, v76
    v_exp_f32 v77, v77
    v_perm_b32 v93, v75, v74, s71
    v_exp_f32 v78, v78
    v_exp_f32 v79, v79
    v_perm_b32 v94, v77, v76, s71
    s_setprio 3
    v_mfma_f32_32x32x16_bf16 a[48:63], v[120:123], v[88:91], a[48:63]
    v_perm_b32 v95, v79, v78, s71
    s_lshl_b32 s65, s3, 10
    s_add_u32 s65, s65, 97280
    v_mfma_f32_32x32x16_bf16 a[48:63], v[124:127], v[92:95], a[48:63]
    v_add_u32 v7, s65, v15
    s_lshl_b32 s65, s4, 2
    s_add_u32 s65, s65, s5
    s_lshl_b32 s65, s65, 13
    ds_write_b128 v6, a[32:35] offset:8192
    ds_write_b128 v6, a[36:39] offset:9216
    ds_write_b128 v6, a[40:43] offset:10240
    ds_write_b128 v6, a[44:47] offset:11264
    s_lshl_b32 s66, s3, 11
    s_add_u32 s74, s65, s66
    s_add_u32 s74, s74, 6553600
    s_add_u32 s65, s66, 101376
    v_add_u32 v6, s65, v2
    s_nop 1
    s_add_u32 s65, s5, 1
    s_and_b32 s65, s65, 3
    s_lshl_b32 s65, s65, 13
    s_add_u32 s65, s65, s66
    s_lshl_b32 s76, s4, 15
    s_add_u32 s76, s76, s65
    s_add_u32 s76, s76, 6553600
    s_add_u32 s65, s5, 2
    s_and_b32 s65, s65, 3
    s_lshl_b32 s65, s65, 13
    s_add_u32 s65, s65, s66
    s_lshl_b32 s77, s4, 15
    s_add_u32 s77, s77, s65
    s_add_u32 s77, s77, 6553600
    s_add_u32 s65, s5, 3
    s_and_b32 s65, s65, 3
    s_lshl_b32 s65, s65, 13
    s_add_u32 s65, s65, s66
    s_lshl_b32 s78, s4, 15
    s_add_u32 s78, s78, s65
    s_add_u32 s78, s78, 6553600
    v_accvgpr_read_b32 v16, a48
    v_accvgpr_read_b32 v17, a49
    v_accvgpr_read_b32 v18, a50
    v_accvgpr_read_b32 v19, a51
    v_accvgpr_read_b32 v20, a52
    v_accvgpr_read_b32 v21, a53
    v_accvgpr_read_b32 v22, a54
    v_accvgpr_read_b32 v23, a55
    v_accvgpr_read_b32 v24, a56
    v_accvgpr_read_b32 v25, a57
    v_accvgpr_read_b32 v26, a58
    v_accvgpr_read_b32 v27, a59
    v_accvgpr_read_b32 v28, a60
    v_accvgpr_read_b32 v29, a61
    v_accvgpr_read_b32 v30, a62
    v_accvgpr_read_b32 v31, a63
    s_waitcnt lgkmcnt(0)
    s_barrier
    ds_read_b128 v[48:51], v12 offset:0
    ds_read_b128 v[52:55], v12 offset:1024
    ds_read_b128 v[56:59], v12 offset:2048
    ds_read_b128 v[60:63], v12 offset:3072
    ds_read_b128 v[64:67], v13 offset:0
    ds_read_b128 v[68:71], v13 offset:1024
    ds_read_b128 v[72:75], v13 offset:2048
    ds_read_b128 v[76:79], v13 offset:3072
    ds_read_b128 v[80:83], v14 offset:0
    ds_read_b128 v[84:87], v14 offset:1024
    ds_read_b128 v[88:91], v14 offset:2048
    ds_read_b128 v[92:95], v14 offset:3072
    s_cmp_lg_u32 s82, 0
    s_cbranch_scc1 A_RESCALE
A_SUM:
    s_waitcnt lgkmcnt(8)
    v_pk_add_f32 v[28:29], v[28:29], v[60:61]
    v_pk_add_f32 v[16:17], v[16:17], v[48:49]
    v_pk_add_f32 v[18:19], v[18:19], v[50:51]
    v_pk_add_f32 v[20:21], v[20:21], v[52:53]
    v_pk_add_f32 v[22:23], v[22:23], v[54:55]
    v_pk_add_f32 v[24:25], v[24:25], v[56:57]
    v_pk_add_f32 v[26:27], v[26:27], v[58:59]
    v_pk_add_f32 v[30:31], v[30:31], v[62:63]
    s_waitcnt lgkmcnt(4)
    v_pk_add_f32 v[28:29], v[28:29], v[76:77]
    v_pk_add_f32 v[16:17], v[16:17], v[64:65]
    v_pk_add_f32 v[18:19], v[18:19], v[66:67]
    v_pk_add_f32 v[20:21], v[20:21], v[68:69]
    v_pk_add_f32 v[22:23], v[22:23], v[70:71]
    v_pk_add_f32 v[24:25], v[24:25], v[72:73]
    v_pk_add_f32 v[26:27], v[26:27], v[74:75]
    v_pk_add_f32 v[30:31], v[30:31], v[78:79]
    s_waitcnt lgkmcnt(0)
    v_pk_add_f32 v[28:29], v[28:29], v[92:93]
    v_mov_b32 v36, v28
    v_mov_b32 v37, v28
    v_pk_add_f32 v[16:17], v[16:17], v[80:81]
    v_pk_add_f32 v[18:19], v[18:19], v[82:83]
    v_permlane32_swap_b32 v36, v37
    v_pk_add_f32 v[20:21], v[20:21], v[84:85]
    v_pk_add_f32 v[22:23], v[22:23], v[86:87]
    v_rcp_f32 v37, v37
    v_pk_add_f32 v[24:25], v[24:25], v[88:89]
    v_pk_add_f32 v[26:27], v[26:27], v[90:91]
    v_mul_f32 v37, v98, v37
    v_pk_add_f32 v[30:31], v[30:31], v[94:95]
    s_mov_b32 s75, 0xfffffffe
    v_pk_mul_f32 v[16:17], v[16:17], v[36:37] op_sel:[0,1] op_sel_hi:[1,1]
    v_pk_mul_f32 v[18:19], v[18:19], v[36:37] op_sel:[0,1] op_sel_hi:[1,1]
    v_pk_mul_f32 v[20:21], v[20:21], v[36:37] op_sel:[0,1] op_sel_hi:[1,1]
    v_pk_mul_f32 v[22:23], v[22:23], v[36:37] op_sel:[0,1] op_sel_hi:[1,1]
    v_pk_mul_f32 v[24:25], v[24:25], v[36:37] op_sel:[0,1] op_sel_hi:[1,1]
    v_pk_mul_f32 v[26:27], v[26:27], v[36:37] op_sel:[0,1] op_sel_hi:[1,1]
    v_pk_mul_f32 v[28:29], v[28:29], v[36:37] op_sel:[0,1] op_sel_hi:[1,1]
    v_pk_mul_f32 v[30:31], v[30:31], v[36:37] op_sel:[0,1] op_sel_hi:[1,1]
    v_cvt_pk_bf16_f32 v40, v16, v17
    v_cvt_pk_bf16_f32 v41, v18, v19
    v_cvt_pk_bf16_f32 v42, v20, v21
    v_cvt_pk_bf16_f32 v43, v22, v23
    v_cvt_pk_bf16_f32 v44, v24, v25
    v_cvt_pk_bf16_f32 v45, v26, v27
    v_cvt_pk_bf16_f32 v46, v28, v29
    v_cvt_pk_bf16_f32 v47, v30, v31
    v_min_u32 v40, s75, v40
    v_min_u32 v44, s75, v44
    v_cndmask_b32 v46, v46, 0, s[62:63]
    v_cndmask_b32 v47, v47, 0, s[62:63]
    buffer_store_dwordx4 v[40:43], v2, s[44:47], s74 offen nt
    buffer_store_dwordx4 v[44:47], v2, s[44:47], s74 offen offset:1024 nt
    ds_write_b128 v6, v[40:43]
    ds_write_b128 v6, v[44:47] offset:1024
    s_mov_b64 exec, 1
    ds_add_u32 v3, v4 offset:18512
    s_mov_b64 exec, -1
    s_mov_b32 s73, 14
    s_mov_b32 s72, 0
A_GATHER:
    s_cmp_eq_u32 s73, 14
    s_cbranch_scc0 A_GSOME
    buffer_load_dwordx4 v[104:107], v2, s[44:47], s76 offen sc1
    buffer_load_dwordx4 v[108:111], v2, s[44:47], s76 offen offset:1024 sc1
    buffer_load_dwordx4 v[112:115], v2, s[44:47], s77 offen sc1
    buffer_load_dwordx4 v[116:119], v2, s[44:47], s77 offen offset:1024 sc1
    buffer_load_dwordx4 v[120:123], v2, s[44:47], s78 offen sc1
    buffer_load_dwordx4 v[124:127], v2, s[44:47], s78 offen offset:1024 sc1
    s_waitcnt vmcnt(4)
    v_max_u32 v16, v104, v108
    v_cmp_eq_u32 vcc, -1, v16
    s_cbranch_vccnz A_GF1
    ds_write_b128 v6, v[104:107] offset:8192
    ds_write_b128 v6, v[108:111] offset:9216
    s_bitset0_b32 s73, 1
    s_mov_b64 exec, 1
    ds_add_u32 v3, v4 offset:18516
    s_mov_b64 exec, -1
A_GF1:
    s_waitcnt vmcnt(2)
    v_max_u32 v16, v112, v116
    v_cmp_eq_u32 vcc, -1, v16
    s_cbranch_vccnz A_GF2
    ds_write_b128 v6, v[112:115] offset:16384
    ds_write_b128 v6, v[116:119] offset:17408
    s_bitset0_b32 s73, 2
    s_mov_b64 exec, 1
    ds_add_u32 v3, v4 offset:18520
    s_mov_b64 exec, -1
A_GF2:
    s_waitcnt vmcnt(0)
    v_max_u32 v16, v120, v124
    v_cmp_eq_u32 vcc, -1, v16
    s_cbranch_vccnz A_GF3
    ds_write_b128 v6, v[120:123] offset:24576
    ds_write_b128 v6, v[124:127] offset:25600
    s_bitset0_b32 s73, 3
    s_mov_b64 exec, 1
    ds_add_u32 v3, v4 offset:18524
    s_mov_b64 exec, -1
A_GF3:
    s_branch A_GEND
A_GSOME:
    s_bitcmp0_b32 s73, 1
    s_cbranch_scc1 A_GL1
    buffer_load_dwordx4 v[104:107], v2, s[44:47], s76 offen sc1
    buffer_load_dwordx4 v[108:111], v2, s[44:47], s76 offen offset:1024 sc1
A_GL1:
    s_bitcmp0_b32 s73, 2
    s_cbranch_scc1 A_GL2
    buffer_load_dwordx4 v[112:115], v2, s[44:47], s77 offen sc1
    buffer_load_dwordx4 v[116:119], v2, s[44:47], s77 offen offset:1024 sc1
A_GL2:
    s_bitcmp0_b32 s73, 3
    s_cbranch_scc1 A_GL3
    buffer_load_dwordx4 v[120:123], v2, s[44:47], s78 offen sc1
    buffer_load_dwordx4 v[124:127], v2, s[44:47], s78 offen offset:1024 sc1
A_GL3:
    s_waitcnt vmcnt(0)
    s_bitcmp0_b32 s73, 1
    s_cbranch_scc1 A_GC1
    v_max_u32 v16, v104, v108
    v_cmp_eq_u32 vcc, -1, v16
    s_cbranch_vccnz A_GC1
    ds_write_b128 v6, v[104:107] offset:8192
    ds_write_b128 v6, v[108:111] offset:9216
    s_bitset0_b32 s73, 1
    s_mov_b64 exec, 1
    ds_add_u32 v3, v4 offset:18516
    s_mov_b64 exec, -1
A_GC1:
    s_bitcmp0_b32 s73, 2
    s_cbranch_scc1 A_GC2
    v_max_u32 v16, v112, v116
    v_cmp_eq_u32 vcc, -1, v16
    s_cbranch_vccnz A_GC2
    ds_write_b128 v6, v[112:115] offset:16384
    ds_write_b128 v6, v[116:119] offset:17408
    s_bitset0_b32 s73, 2
    s_mov_b64 exec, 1
    ds_add_u32 v3, v4 offset:18520
    s_mov_b64 exec, -1
A_GC2:
    s_bitcmp0_b32 s73, 3
    s_cbranch_scc1 A_GC3
    v_max_u32 v16, v120, v124
    v_cmp_eq_u32 vcc, -1, v16
    s_cbranch_vccnz A_GC3
    ds_write_b128 v6, v[120:123] offset:24576
    ds_write_b128 v6, v[124:127] offset:25600
    s_bitset0_b32 s73, 3
    s_mov_b64 exec, 1
    ds_add_u32 v3, v4 offset:18524
    s_mov_b64 exec, -1
A_GC3:
A_GEND:
    s_cmp_eq_u32 s73, 0
    s_cbranch_scc1 A_DONE
    s_sub_u32 s61, s61, 1
    s_cbranch_scc1 BAIL
    s_add_u32 s72, s72, 1
    s_and_b32 s65, s72, 7
    s_cmp_lg_u32 s65, 0
    s_cbranch_scc1 A_GATHER
    v_add_u32 v16, s5, v1
    v_and_b32 v16, 3, v16
    v_lshlrev_b32 v16, 8, v16
    s_lshl_b32 s65, s4, 10
    s_lshl_b32 s66, s3, 6
    s_add_u32 s65, s65, s66
    s_add_u32 s65, s65, 327680
    buffer_load_dword v17, v16, s[44:47], s65 offen sc1
    s_waitcnt vmcnt(0)
    v_readlane_b32 s65, v17, 1
    s_cmp_eq_u32 s65, s60
    s_cselect_b32 s65, 3932160, 0
    s_cmp_ge_u32 s76, 6553600
    s_cselect_b32 s65, s65, 0
    s_sub_u32 s76, s76, s65
    v_readlane_b32 s65, v17, 2
    s_cmp_eq_u32 s65, s60
    s_cselect_b32 s65, 3932160, 0
    s_cmp_ge_u32 s77, 6553600
    s_cselect_b32 s65, s65, 0
    s_sub_u32 s77, s77, s65
    v_readlane_b32 s65, v17, 3
    s_cmp_eq_u32 s65, s60
    s_cselect_b32 s65, 3932160, 0
    s_cmp_ge_u32 s78, 6553600
    s_cselect_b32 s65, s65, 0
    s_sub_u32 s78, s78, s65
    s_branch A_GATHER
A_DONE:
A_NWB:
    s_waitcnt lgkmcnt(0)
    s_endpgm
A_C7WAIT:
W29:
    ds_read_b32 v5, v3 offset:18484
    s_waitcnt lgkmcnt(0)
    v_readfirstlane_b32 s64, v5
    s_cmp_ge_u32 s64, 4
    s_cbranch_scc1 D30
    s_sub_u32 s61, s61, 1
    s_cbranch_scc1 BAIL
    s_sleep 1
    s_branch W29
D30:
    s_branch A_C7OK
A_RL0:
    s_sub_u32 s61, s61, 1
    s_cbranch_scc1 BAIL
    s_sub_u32 s65, s70, 4096
    s_and_b32 s65, s65, 0xffff
    s_waitcnt vmcnt(0)
    buffer_load_dwordx4 v[96:99], v2, s[52:55], s65 offen offset:0 sc1
    buffer_load_dwordx4 v[100:103], v2, s[52:55], s65 offen offset:1024 sc1
    s_waitcnt vmcnt(0)
    v_max_u32 v7, v96, v100
    v_cmp_eq_u32 vcc, -1, v7
    s_nop 0
    s_cbranch_vccnz A_RL0
    s_branch A_RB0
A_RL1:
    s_sub_u32 s61, s61, 1
    s_cbranch_scc1 BAIL
    s_sub_u32 s65, s70, 4096
    s_and_b32 s65, s65, 0xffff
    s_waitcnt vmcnt(0)
    buffer_load_dwordx4 v[104:107], v2, s[52:55], s65 offen offset:2048 sc1
    buffer_load_dwordx4 v[108:111], v2, s[52:55], s65 offen offset:3072 sc1
    s_waitcnt vmcnt(0)
    v_max_u32 v7, v104, v108
    v_cmp_eq_u32 vcc, -1, v7
    s_nop 0
    s_cbranch_vccnz A_RL1
    s_branch A_RB1
A_RL2:
    s_sub_u32 s61, s61, 1
    s_cbranch_scc1 BAIL
    s_sub_u32 s65, s70, 4096
    s_and_b32 s65, s65, 0xffff
    s_waitcnt vmcnt(0)
    buffer_load_dwordx4 v[112:115], v2, s[52:55], s65 offen offset:0 sc1
    buffer_load_dwordx4 v[116:119], v2, s[52:55], s65 offen offset:1024 sc1
    s_waitcnt vmcnt(0)
    v_max_u32 v7, v112, v116
    v_cmp_eq_u32 vcc, -1, v7
    s_nop 0
    s_cbranch_vccnz A_RL2
    s_branch A_RB2
A_RL3:
    s_sub_u32 s61, s61, 1
    s_cbranch_scc1 BAIL
    s_sub_u32 s65, s70, 4096
    s_and_b32 s65, s65, 0xffff
    s_waitcnt vmcnt(0)
    buffer_load_dwordx4 v[120:123], v2, s[52:55], s65 offen offset:2048 sc1
    buffer_load_dwordx4 v[124:127], v2, s[52:55], s65 offen offset:3072 sc1
    s_waitcnt vmcnt(0)
    v_max_u32 v7, v120, v124
    v_cmp_eq_u32 vcc, -1, v7
    s_nop 0
    s_cbranch_vccnz A_RL3
    s_branch A_RB3
A_RL4:
    s_sub_u32 s61, s61, 1
    s_cbranch_scc1 BAIL
    s_sub_u32 s65, s70, 4096
    s_and_b32 s65, s65, 0xffff
    s_waitcnt vmcnt(0)
    buffer_load_dwordx4 v[96:99], v2, s[52:55], s65 offen offset:0 sc1
    buffer_load_dwordx4 v[100:103], v2, s[52:55], s65 offen offset:1024 sc1
    s_waitcnt vmcnt(0)
    v_max_u32 v7, v96, v100
    v_cmp_eq_u32 vcc, -1, v7
    s_nop 0
    s_cbranch_vccnz A_RL4
    s_branch A_RB4
A_RL5:
    s_sub_u32 s61, s61, 1
    s_cbranch_scc1 BAIL
    s_sub_u32 s65, s70, 4096
    s_and_b32 s65, s65, 0xffff
    s_waitcnt vmcnt(0)
    buffer_load_dwordx4 v[104:107], v2, s[52:55], s65 offen offset:2048 sc1
    buffer_load_dwordx4 v[108:111], v2, s[52:55], s65 offen offset:3072 sc1
    s_waitcnt vmcnt(0)
    v_max_u32 v7, v104, v108
    v_cmp_eq_u32 vcc, -1, v7
    s_nop 0
    s_cbranch_vccnz A_RL5
    s_branch A_RB5
A_RL6:
    s_sub_u32 s61, s61, 1
    s_cbranch_scc1 BAIL
    s_sub_u32 s65, s70, 4096
    s_and_b32 s65, s65, 0xffff
    s_waitcnt vmcnt(0)
    buffer_load_dwordx4 v[112:115], v2, s[52:55], s65 offen offset:0 sc1
    buffer_load_dwordx4 v[116:119], v2, s[52:55], s65 offen offset:1024 sc1
    s_waitcnt vmcnt(0)
    v_max_u32 v7, v112, v116
    v_cmp_eq_u32 vcc, -1, v7
    s_nop 0
    s_cbranch_vccnz A_RL6
    s_branch A_RB6
A_RL7:
    s_sub_u32 s61, s61, 1
    s_cbranch_scc1 BAIL
    s_sub_u32 s65, s70, 4096
    s_and_b32 s65, s65, 0xffff
    s_waitcnt vmcnt(0)
    buffer_load_dwordx4 v[120:123], v2, s[52:55], s65 offen offset:2048 sc1
    buffer_load_dwordx4 v[124:127], v2, s[52:55], s65 offen offset:3072 sc1
    s_waitcnt vmcnt(0)
    v_max_u32 v7, v120, v124
    v_cmp_eq_u32 vcc, -1, v7
    s_nop 0
    s_cbranch_vccnz A_RL7
    s_branch A_RB7
A_RESCALE:
    ds_read2st64_b32 v[32:33], v7 offset0:0 offset1:1
    ds_read2st64_b32 v[34:35], v7 offset0:2 offset1:3
    s_waitcnt lgkmcnt(0)
    v_min_f32 v36, v32, v33
    v_min3_f32 v36, v36, v34, v35
    v_sub_f32 v32, v36, v32
    v_sub_f32 v33, v36, v33
    v_sub_f32 v34, v36, v34
    v_sub_f32 v35, v36, v35
    v_exp_f32 v32, v32
    v_exp_f32 v33, v33
    v_exp_f32 v34, v34
    v_exp_f32 v35, v35
    s_nop 0
    v_mul_f32 v16, v35, v16
    v_mul_f32 v17, v35, v17
    v_mul_f32 v18, v35, v18
    v_mul_f32 v19, v35, v19
    v_mul_f32 v20, v35, v20
    v_mul_f32 v21, v35, v21
    v_mul_f32 v22, v35, v22
    v_mul_f32 v23, v35, v23
    v_mul_f32 v24, v35, v24
    v_mul_f32 v25, v35, v25
    v_mul_f32 v26, v35, v26
    v_mul_f32 v27, v35, v27
    v_mul_f32 v28, v35, v28
    v_mul_f32 v29, v35, v29
    v_mul_f32 v30, v35, v30
    v_mul_f32 v31, v35, v31
    v_mul_f32 v48, v32, v48
    v_mul_f32 v49, v32, v49
    v_mul_f32 v50, v32, v50
    v_mul_f32 v51, v32, v51
    v_mul_f32 v52, v32, v52
    v_mul_f32 v53, v32, v53
    v_mul_f32 v54, v32, v54
    v_mul_f32 v55, v32, v55
    v_mul_f32 v56, v32, v56
    v_mul_f32 v57, v32, v57
    v_mul_f32 v58, v32, v58
    v_mul_f32 v59, v32, v59
    v_mul_f32 v60, v32, v60
    v_mul_f32 v61, v32, v61
    v_mul_f32 v62, v32, v62
    v_mul_f32 v63, v32, v63
    v_mul_f32 v64, v33, v64
    v_mul_f32 v65, v33, v65
    v_mul_f32 v66, v33, v66
    v_mul_f32 v67, v33, v67
    v_mul_f32 v68, v33, v68
    v_mul_f32 v69, v33, v69
    v_mul_f32 v70, v33, v70
    v_mul_f32 v71, v33, v71
    v_mul_f32 v72, v33, v72
    v_mul_f32 v73, v33, v73
    v_mul_f32 v74, v33, v74
    v_mul_f32 v75, v33, v75
    v_mul_f32 v76, v33, v76
    v_mul_f32 v77, v33, v77
    v_mul_f32 v78, v33, v78
    v_mul_f32 v79, v33, v79
    v_mul_f32 v80, v34, v80
    v_mul_f32 v81, v34, v81
    v_mul_f32 v82, v34, v82
    v_mul_f32 v83, v34, v83
    v_mul_f32 v84, v34, v84
    v_mul_f32 v85, v34, v85
    v_mul_f32 v86, v34, v86
    v_mul_f32 v87, v34, v87
    v_mul_f32 v88, v34, v88
    v_mul_f32 v89, v34, v89
    v_mul_f32 v90, v34, v90
    v_mul_f32 v91, v34, v91
    v_mul_f32 v92, v34, v92
    v_mul_f32 v93, v34, v93
    v_mul_f32 v94, v34, v94
    v_mul_f32 v95, v34, v95
    s_branch A_SUM
A_UNSAFE:
    s_cmp_eq_u32 s82, 0
    s_cbranch_scc1 A_FALLBACK
    s_add_u32 s65, s3, 1
    s_and_b32 s65, s65, 3
    s_lshl_b32 s65, s65, 10
    s_add_u32 s65, s65, 97280
    v_add_u32 v7, s65, v15
    ds_write_b32 v7, v8
    s_add_u32 s65, s3, 2
    s_and_b32 s65, s65, 3
    s_lshl_b32 s65, s65, 10
    s_add_u32 s65, s65, 97536
    v_add_u32 v7, s65, v15
    ds_write_b32 v7, v9
    s_add_u32 s65, s3, 3
    s_and_b32 s65, s65, 3
    s_lshl_b32 s65, s65, 10
    s_add_u32 s65, s65, 97792
    v_add_u32 v7, s65, v15
    ds_write_b32 v7, v10
    s_add_u32 s65, s3, 4
    s_and_b32 s65, s65, 3
    s_lshl_b32 s65, s65, 10
    s_add_u32 s65, s65, 98048
    v_add_u32 v7, s65, v15
    ds_write_b32 v7, v11
    s_branch A_SAFE
A_FALLBACK:
    s_mov_b32 s82, 1
    s_mov_b32 s74, 0
    s_mov_b32 s75, 16
    s_nop 15
    v_mov_b32 v48, 0xff800000
    v_mov_b32 v49, 0xff800000
    v_mov_b32 v50, 0xff800000
    v_mov_b32 v51, 0xff800000
A_FB_LOOP:
    buffer_load_dwordx4 v[52:55], v2, s[52:55], s74 offen sc1
    buffer_load_dwordx4 v[56:59], v2, s[52:55], s74 offen offset:1024 sc1
    s_add_u32 s74, s74, 4096
    s_waitcnt vmcnt(0)
    v_mfma_f32_32x32x16_bf16 v[64:79], v[52:55], v[16:19], 0
    v_mfma_f32_32x32x16_bf16 v[64:79], v[56:59], v[20:23], v[64:79]
    s_nop 11
    v_max3_f32 v48, v48, v64, v65
    v_max3_f32 v48, v48, v66, v67
    v_max3_f32 v48, v48, v68, v69
    v_max3_f32 v48, v48, v70, v71
    v_max3_f32 v48, v48, v72, v73
    v_max3_f32 v48, v48, v74, v75
    v_max3_f32 v48, v48, v76, v77
    v_max3_f32 v48, v48, v78, v79
    v_mfma_f32_32x32x16_bf16 v[64:79], v[52:55], v[24:27], 0
    v_mfma_f32_32x32x16_bf16 v[64:79], v[56:59], v[28:31], v[64:79]
    s_nop 11
    v_max3_f32 v49, v49, v64, v65
    v_max3_f32 v49, v49, v66, v67
    v_max3_f32 v49, v49, v68, v69
    v_max3_f32 v49, v49, v70, v71
    v_max3_f32 v49, v49, v72, v73
    v_max3_f32 v49, v49, v74, v75
    v_max3_f32 v49, v49, v76, v77
    v_max3_f32 v49, v49, v78, v79
    v_mfma_f32_32x32x16_bf16 v[64:79], v[52:55], v[32:35], 0
    v_mfma_f32_32x32x16_bf16 v[64:79], v[56:59], v[36:39], v[64:79]
    s_nop 11
    v_max3_f32 v50, v50, v64, v65
    v_max3_f32 v50, v50, v66, v67
    v_max3_f32 v50, v50, v68, v69
    v_max3_f32 v50, v50, v70, v71
    v_max3_f32 v50, v50, v72, v73
    v_max3_f32 v50, v50, v74, v75
    v_max3_f32 v50, v50, v76, v77
    v_max3_f32 v50, v50, v78, v79
    v_mfma_f32_32x32x16_bf16 v[64:79], v[52:55], v[40:43], 0
    v_mfma_f32_32x32x16_bf16 v[64:79], v[56:59], v[44:47], v[64:79]
    s_nop 11
    v_max3_f32 v51, v51, v64, v65
    v_max3_f32 v51, v51, v66, v67
    v_max3_f32 v51, v51, v68, v69
    v_max3_f32 v51, v51, v70, v71
    v_max3_f32 v51, v51, v72, v73
    v_max3_f32 v51, v51, v74, v75
    v_max3_f32 v51, v51, v76, v77
    v_max3_f32 v51, v51, v78, v79
    s_sub_u32 s75, s75, 1
    s_cmp_lg_u32 s75, 0
    s_cbranch_scc1 A_FB_LOOP
    s_add_u32 s70, s80, 4096
    buffer_load_dwordx4 v[96:99], v2, s[52:55], s80 offen sc1
    buffer_load_dwordx4 v[100:103], v2, s[52:55], s80 offen offset:1024 sc1
    buffer_load_dwordx4 v[104:107], v2, s[52:55], s80 offen offset:2048 sc1
    buffer_load_dwordx4 v[108:111], v2, s[52:55], s80 offen offset:3072 sc1
    buffer_load_dwordx4 v[112:115], v2, s[52:55], s70 offen sc1
    buffer_load_dwordx4 v[116:119], v2, s[52:55], s70 offen offset:1024 sc1
    v_mov_b32 v52, v48
    v_mov_b32 v53, v49
    v_mov_b32 v54, v50
    v_mov_b32 v55, v51
    s_nop 0
    v_permlane32_swap_b32 v48, v52
    v_permlane32_swap_b32 v49, v53
    v_permlane32_swap_b32 v50, v54
    v_permlane32_swap_b32 v51, v55
    s_nop 0
    v_max_f32 v48, v48, v52
    v_sub_f32 v48, 0, v48
    v_cvt_pk_bf16_f32 v56, v48, v48
    v_and_b32 v60, 0xffff0000, v56
    v_sub_f32 v48, v48, v60
    v_cvt_pk_bf16_f32 v58, v48, v48
    v_and_b32 v57, 0xffff0000, v58
    v_sub_f32 v48, v48, v57
    v_cvt_pk_bf16_f32 v59, v48, 0
    v_and_b32 v56, 0xffff, v56
    v_or_b32 v56, v56, v57
    v_cndmask_b32 v22, v22, v56, s[62:63]
    v_cndmask_b32 v23, v23, v59, s[62:63]
    v_lshlrev_b32 v59, 16, v59
    v_add_f32 v57, v57, v59
    v_add_f32 v8, v60, v57
    v_max_f32 v49, v49, v53
    v_sub_f32 v49, 0, v49
    v_cvt_pk_bf16_f32 v56, v49, v49
    v_and_b32 v60, 0xffff0000, v56
    v_sub_f32 v49, v49, v60
    v_cvt_pk_bf16_f32 v58, v49, v49
    v_and_b32 v57, 0xffff0000, v58
    v_sub_f32 v49, v49, v57
    v_cvt_pk_bf16_f32 v59, v49, 0
    v_and_b32 v56, 0xffff, v56
    v_or_b32 v56, v56, v57
    v_cndmask_b32 v30, v30, v56, s[62:63]
    v_cndmask_b32 v31, v31, v59, s[62:63]
    v_lshlrev_b32 v59, 16, v59
    v_add_f32 v57, v57, v59
    v_add_f32 v9, v60, v57
    v_max_f32 v50, v50, v54
    v_sub_f32 v50, 0, v50
    v_cvt_pk_bf16_f32 v56, v50, v50
    v_and_b32 v60, 0xffff0000, v56
    v_sub_f32 v50, v50, v60
    v_cvt_pk_bf16_f32 v58, v50, v50
    v_and_b32 v57, 0xffff0000, v58
    v_sub_f32 v50, v50, v57
    v_cvt_pk_bf16_f32 v59, v50, 0
    v_and_b32 v56, 0xffff, v56
    v_or_b32 v56, v56, v57
    v_cndmask_b32 v38, v38, v56, s[62:63]
    v_cndmask_b32 v39, v39, v59, s[62:63]
    v_lshlrev_b32 v59, 16, v59
    v_add_f32 v57, v57, v59
    v_add_f32 v10, v60, v57
    v_max_f32 v51, v51, v55
    v_sub_f32 v51, 0, v51
    v_cvt_pk_bf16_f32 v56, v51, v51
    v_and_b32 v60, 0xffff0000, v56
    v_sub_f32 v51, v51, v60
    v_cvt_pk_bf16_f32 v58, v51, v51
    v_and_b32 v57, 0xffff0000, v58
    v_sub_f32 v51, v51, v57
    v_cvt_pk_bf16_f32 v59, v51, 0
    v_and_b32 v56, 0xffff, v56
    v_or_b32 v56, v56, v57
    v_cndmask_b32 v46, v46, v56, s[62:63]
    v_cndmask_b32 v47, v47, v59, s[62:63]
    v_lshlrev_b32 v59, 16, v59
    v_add_f32 v57, v57, v59
    v_add_f32 v11, v60, v57
    v_accvgpr_write_b32 a0, 0
    v_accvgpr_write_b32 a1, 0
    v_accvgpr_write_b32 a2, 0
    v_accvgpr_write_b32 a3, 0
    v_accvgpr_write_b32 a4, 0
    v_accvgpr_write_b32 a5, 0
    v_accvgpr_write_b32 a6, 0
    v_accvgpr_write_b32 a7, 0
    v_accvgpr_write_b32 a8, 0
    v_accvgpr_write_b32 a9, 0
    v_accvgpr_write_b32 a10, 0
    v_accvgpr_write_b32 a11, 0
    v_accvgpr_write_b32 a12, 0
    v_accvgpr_write_b32 a13, 0
    v_accvgpr_write_b32 a14, 0
    v_accvgpr_write_b32 a15, 0
    v_accvgpr_write_b32 a16, 0
    v_accvgpr_write_b32 a17, 0
    v_accvgpr_write_b32 a18, 0
    v_accvgpr_write_b32 a19, 0
    v_accvgpr_write_b32 a20, 0
    v_accvgpr_write_b32 a21, 0
    v_accvgpr_write_b32 a22, 0
    v_accvgpr_write_b32 a23, 0
    v_accvgpr_write_b32 a24, 0
    v_accvgpr_write_b32 a25, 0
    v_accvgpr_write_b32 a26, 0
    v_accvgpr_write_b32 a27, 0
    v_accvgpr_write_b32 a28, 0
    v_accvgpr_write_b32 a29, 0
    v_accvgpr_write_b32 a30, 0
    v_accvgpr_write_b32 a31, 0
    v_accvgpr_write_b32 a32, 0
    v_accvgpr_write_b32 a33, 0
    v_accvgpr_write_b32 a34, 0
    v_accvgpr_write_b32 a35, 0
    v_accvgpr_write_b32 a36, 0
    v_accvgpr_write_b32 a37, 0
    v_accvgpr_write_b32 a38, 0
    v_accvgpr_write_b32 a39, 0
    v_accvgpr_write_b32 a40, 0
    v_accvgpr_write_b32 a41, 0
    v_accvgpr_write_b32 a42, 0
    v_accvgpr_write_b32 a43, 0
    v_accvgpr_write_b32 a44, 0
    v_accvgpr_write_b32 a45, 0
    v_accvgpr_write_b32 a46, 0
    v_accvgpr_write_b32 a47, 0
    v_accvgpr_write_b32 a48, 0
    v_accvgpr_write_b32 a49, 0
    v_accvgpr_write_b32 a50, 0
    v_accvgpr_write_b32 a51, 0
    v_accvgpr_write_b32 a52, 0
    v_accvgpr_write_b32 a53, 0
    v_accvgpr_write_b32 a54, 0
    v_accvgpr_write_b32 a55, 0
    v_accvgpr_write_b32 a56, 0
    v_accvgpr_write_b32 a57, 0
    v_accvgpr_write_b32 a58, 0
    v_accvgpr_write_b32 a59, 0
    v_accvgpr_write_b32 a60, 0
    v_accvgpr_write_b32 a61, 0
    v_accvgpr_write_b32 a62, 0
    v_accvgpr_write_b32 a63, 0
    v_mov_b32 v88, 0
    v_mov_b32 v120, 0
    v_mov_b32 v89, 0
    v_mov_b32 v121, 0
    v_mov_b32 v90, 0
    v_mov_b32 v122, 0
    v_mov_b32 v91, 0
    v_mov_b32 v123, 0
    v_mov_b32 v92, 0
    v_mov_b32 v124, 0
    v_mov_b32 v93, 0
    v_mov_b32 v125, 0
    v_mov_b32 v94, 0
    v_mov_b32 v126, 0
    v_mov_b32 v95, 0
    v_mov_b32 v127, 0
    s_waitcnt vmcnt(2)
    s_branch A_MAIN
HELPER:
    s_setprio 2
    s_sub_u32 s3, s3, 4
    s_lshr_b32 s6, s3, 1
    s_and_b32 s7, s3, 1
    s_min_u32 s76, s2, 223
    s_or_b32 s65, s2, s3
    s_cmp_lg_u32 s65, 0
    s_cbranch_scc1 H_NON
    s_memrealtime s[66:67]
    s_waitcnt lgkmcnt(0)
    s_or_b32 s66, s66, 1
    v_mov_b32 v5, s66
    global_store_dword v3, v5, s[40:41] sc0 sc1
H_NON:
    s_lshl_b32 s65, s76, 2
    s_load_dword s66, s[32:33], s65
    s_load_dword s67, s[34:35], s65
    s_lshl_b32 s65, s76, 10
    s_lshl_b32 s68, s3, 8
    s_add_u32 s65, s65, s68
    v_lshl_add_u32 v8, v1, 2, s65
    global_load_dword v96, v8, s[20:21]
    global_load_dword v97, v8, s[22:23]
    global_load_dword v98, v8, s[24:25]
    global_load_dword v99, v8, s[26:27]
    global_load_dword v100, v8, s[28:29]
    global_load_dword v101, v8, s[30:31]
    s_barrier
    s_mov_b32 s48, s16
    s_mov_b32 s49, s17
    s_mov_b32 s50, 401408
    s_mov_b32 s51, 0x00020000
    s_mul_i32 s77, s3, 4608
    v_and_b32 v9, 15, v1
    v_lshrrev_b32 v10, 4, v1
    s_mov_b32 s8, 0xaaaaaaaa
    s_mov_b32 s9, s8
    s_mov_b32 s10, 0xcccccccc
    s_mov_b32 s11, s10
    s_mov_b32 s12, 0xf0f0f0f0
    s_mov_b32 s13, s12
    s_mov_b32 s14, 0xff00ff00
    s_mov_b32 s15, s14
    v_mul_u32_u24 v12, 1088, v10
    v_lshl_add_u32 v12, v9, 2, v12
    v_add_u32 v12, s77, v12
    s_lshl_b32 s68, s6, 4
    s_lshl_b32 s78, s6, 2
    v_mov_b32 v6, s78
    v_lshlrev_b32 v14, 2, v10
    v_xor_b32 v14, v9, v14
    v_mul_u32_u24 v15, 896, v10
    v_lshl_add_u32 v14, v14, 4, v15
    v_accvgpr_write_b32 a8, v14
    v_lshlrev_b32 v14, 3, v10
    v_sub_u32 v14, v14, v9
    v_add_u32 v14, 2031, v14
    v_and_b32 v15, 1, v14
    v_lshrrev_b32 v14, 1, v14
    v_mul_u32_u24 v15, 4224, v15
    v_lshl_add_u32 v14, v14, 2, v15
    s_mul_i32 s65, s6, 8384
    s_lshl_b32 s69, s7, 8
    s_sub_u32 s65, s65, s69
    s_add_u32 s65, s65, 18240
    v_add_u32 v14, s65, v14
    v_accvgpr_write_b32 a9, v14
    v_lshlrev_b32 v14, 5, v9
    v_lshl_add_u32 v14, v10, 4, v14
    s_mul_i32 s65, s6, 6144
    s_sub_u32 s65, s65, s69
    s_add_u32 s65, s65, 36000
    v_add_u32 v14, s65, v14
    v_accvgpr_write_b32 a10, v14
    v_lshrrev_b32 v16, 5, v1
    v_and_b32 v14, 1, v10
    v_lshlrev_b32 v14, 3, v14
    v_lshrrev_b32 v15, 1, v9
    v_add_u32 v14, v14, v15
    v_mul_u32_u24 v14, 28672, v14
    v_and_b32 v15, 1, v1
    v_lshl_add_u32 v14, v15, 5, v14
    v_lshl_add_u32 v14, v16, 4, v14
    v_accvgpr_write_b32 a11, v14
    v_bfe_u32 v14, v1, 2, 2
    v_lshl_add_u32 v15, v16, 2, v14
    v_lshlrev_b32 v15, 8, v15
    v_and_b32 v17, 1, v10
    v_lshlrev_b32 v17, 5, v17
    v_and_b32 v18, 3, v1
    v_lshl_add_u32 v17, v18, 3, v17
    s_lshl_b32 s65, s3, 6
    v_add_u32 v17, s65, v17
    v_lshlrev_b32 v14, 6, v14
    v_xor_b32 v17, v17, v14
    v_add_u32 v15, v15, v17
    v_accvgpr_write_b32 a12, v15
    v_and_b32 v17, 31, v1
    v_lshlrev_b32 v14, 6, v17
    v_lshl_add_u32 v14, v16, 4, v14
    v_accvgpr_write_b32 a13, v14
    v_mul_u32_u24 v14, 896, v17
    v_lshl_add_u32 v14, v16, 4, v14
    v_accvgpr_write_b32 a14, v14
    s_lshl_b32 s65, s7, 6
    v_add_u32 v14, s65, v1
    s_mul_i32 s69, s6, 9216
    v_lshl_add_u32 v15, v14, 2, s69
    v_accvgpr_write_b32 a15, v15
    v_sub_u32 v14, 127, v14
    s_mul_i32 s65, s6, 8384
    s_add_u32 s65, s65, 18944
    v_lshl_add_u32 v14, v14, 4, s65
    v_accvgpr_write_b32 a16, v14
    v_lshrrev_b32 v14, 2, v1
    v_lshlrev_b32 v14, 7, v14
    v_lshl_add_u32 v14, v18, 4, v14
    v_accvgpr_write_b32 a17, v14
    s_mul_i32 s65, s6, 6144
    s_add_u32 s65, s65, 35712
    v_and_b32 v14, 0x1f0, v2
    v_add_u32 v14, s65, v14
    v_accvgpr_write_b32 a18, v14
    v_lshl_add_u32 v14, v17, 2, s69
    v_subrev_u32 v15, 128, v15
    s_cmp_eq_u32 s7, 0
    s_cselect_b64 vcc, -1, 0
    v_cndmask_b32 v14, v15, v14, vcc
    v_accvgpr_write_b32 a19, v14
    v_accvgpr_write_b32 a24, 0
    v_accvgpr_write_b32 a25, 0
    v_accvgpr_write_b32 a26, 0
    v_accvgpr_write_b32 a27, 0
    v_accvgpr_write_b32 a28, -1
    v_accvgpr_write_b32 a29, -1
    v_accvgpr_write_b32 a30, -1
    v_accvgpr_write_b32 a31, -1
    v_lshrrev_b32 v11, 1, v17
    v_lshlrev_b32 v14, 2, v16
    v_sub_u32 v11, v11, v14
    s_waitcnt lgkmcnt(0)
    s_lshr_b32 s66, s66, s68
    s_lshl_b32 s66, s66, 16
    s_lshr_b32 s67, s67, s68
    s_lshl_b32 s67, s67, 16
    v_mov_b32 v13, s66
    v_mul_f32 v13, 1069066811, v13
    v_exp_f32 v13, v13
    s_nop 0
    v_cvt_pk_bf16_f32 v13, v13, v13
    v_and_b32 v13, 0xffff0000, v13
    v_cmp_eq_u32 s[20:21], 0, v11
    v_cmp_eq_u32 s[22:23], 1, v11
    v_cmp_eq_u32 s[24:25], 2, v11
    v_cmp_eq_u32 s[26:27], 3, v11
    v_cmp_eq_u32 s[28:29], 8, v11
    v_cmp_eq_u32 s[30:31], 9, v11
    v_cmp_eq_u32 s[32:33], 10, v11
    v_cmp_eq_u32 s[34:35], 11, v11
    s_waitcnt vmcnt(0)
    v_and_b32 v102, 0xffff0000, v96
    v_and_b32 v103, 0xffff0000, v97
    v_and_b32 v104, 0xffff0000, v98
    v_and_b32 v105, 0xffff0000, v99
    v_and_b32 v106, 0xffff0000, v100
    v_and_b32 v107, 0xffff0000, v101
    v_accvgpr_write_b32 a0, v102
    v_accvgpr_write_b32 a1, v103
    v_accvgpr_write_b32 a2, v104
    v_accvgpr_write_b32 a3, v105
    v_accvgpr_write_b32 a4, v106
    v_accvgpr_write_b32 a5, v107
    v_lshlrev_b32 v96, 16, v96
    v_lshlrev_b32 v97, 16, v97
    v_lshlrev_b32 v98, 16, v98
    v_lshlrev_b32 v99, 16, v99
    v_lshlrev_b32 v100, 16, v100
    v_lshlrev_b32 v101, 16, v101
    v_mul_f32 v96, v13, v96
    v_mul_f32 v97, v13, v97
    v_mul_f32 v96, 1069066811, v96
    v_mul_f32 v97, 0.15915494, v97
    v_mul_f32 v98, v13, v98
    v_mul_f32 v99, v13, v99
    v_mul_f32 v15, 1090519040, v97
    v_mul_f32 v14, 1090519040, v96
    v_fract_f32 v15, v15
    v_exp_f32 v14, v14
    v_cos_f32 v16, v15
    v_sin_f32 v17, v15
    s_nop 0
    v_mul_f32 v16, v16, v14
    v_mul_f32 v17, v17, v14
    v_fract_f32 v19, v97
    v_exp_f32 v18, v96
    v_cos_f32 v20, v19
    v_sin_f32 v21, v19
    s_nop 0
    v_mul_f32 v20, v20, v18
    v_mul_f32 v21, v21, v18
    v_mul_f32 v23, 1132462080, v97
    v_mul_f32 v22, 1132462080, v96
    v_fract_f32 v23, v23
    v_exp_f32 v22, v22
    v_cos_f32 v24, v23
    v_sin_f32 v25, v23
    s_nop 0
    v_mul_f32 v24, v24, v22
    v_mul_f32 v25, v25, v22
    v_mul_f32 v26, v100, v98
    v_mul_f32 v27, v101, v98
    v_fma_f32 v26, -v101, v99, v26
    v_fmac_f32 v27, v100, v99
    v_xor_b32 v27, 0x80000000, v27
    v_mul_f32 v28, v16, v16
    v_mul_f32 v29, v17, v16
    v_fma_f32 v28, -v17, v17, v28
    v_fmac_f32 v29, v16, v17
    v_cvt_pk_bf16_f32 v48, 1.0, 0
    v_cvt_pk_bf16_f32 v97, v16, v17
    v_mul_f32 v30, v28, v16
    v_mul_f32 v31, v29, v16
    v_fma_f32 v30, -v29, v17, v30
    v_fmac_f32 v31, v28, v17
    v_cvt_pk_bf16_f32 v98, v28, v29
    v_mul_f32 v32, v28, v28
    v_mul_f32 v33, v29, v28
    v_fma_f32 v32, -v29, v29, v32
    v_fmac_f32 v33, v28, v29
    v_cvt_pk_bf16_f32 v51, v30, v31
    v_mul_f32 v34, v16, v32
    v_mul_f32 v35, v17, v32
    v_fma_f32 v34, -v17, v33, v34
    v_fmac_f32 v35, v16, v33
    v_cvt_pk_bf16_f32 v100, v32, v33
    v_mul_f32 v36, v28, v32
    v_mul_f32 v37, v29, v32
    v_fma_f32 v36, -v29, v33, v36
    v_fmac_f32 v37, v28, v33
    v_cvt_pk_bf16_f32 v53, v34, v35
    v_mul_f32 v38, v30, v32
    v_mul_f32 v39, v31, v32
    v_fma_f32 v38, -v31, v33, v38
    v_fmac_f32 v39, v30, v33
    v_cvt_pk_bf16_f32 v54, v36, v37
    v_mul_f32 v40, v32, v32
    v_mul_f32 v41, v33, v32
    v_fma_f32 v40, -v33, v33, v40
    v_fmac_f32 v41, v32, v33
    v_cvt_pk_bf16_f32 v103, v38, v39
    v_mul_f32 v42, v34, v32
    v_mul_f32 v43, v35, v32
    v_fma_f32 v42, -v35, v33, v42
    v_fmac_f32 v43, v34, v33
    v_cvt_pk_bf16_f32 v104, v40, v41
    v_mul_f32 v14, v36, v32
    v_mul_f32 v15, v37, v32
    v_fma_f32 v14, -v37, v33, v14
    v_fmac_f32 v15, v36, v33
    v_cvt_pk_bf16_f32 v57, v42, v43
    v_mul_f32 v18, v38, v32
    v_mul_f32 v19, v39, v32
    v_fma_f32 v18, -v39, v33, v18
    v_fmac_f32 v19, v38, v33
    v_cvt_pk_bf16_f32 v58, v14, v15
    v_mul_f32 v22, v40, v32
    v_mul_f32 v23, v41, v32
    v_fma_f32 v22, -v41, v33, v22
    v_fmac_f32 v23, v40, v33
    v_cvt_pk_bf16_f32 v107, v18, v19
    v_mul_f32 v16, v42, v32
    v_mul_f32 v17, v43, v32
    v_fma_f32 v16, -v43, v33, v16
    v_fmac_f32 v17, v42, v33
    v_cvt_pk_bf16_f32 v60, v22, v23
    v_mul_f32 v28, v14, v32
    v_mul_f32 v29, v15, v32
    v_fma_f32 v28, -v15, v33, v28
    v_fmac_f32 v29, v14, v33
    v_cvt_pk_bf16_f32 v109, v16, v17
    v_mul_f32 v30, v18, v32
    v_mul_f32 v31, v19, v32
    v_fma_f32 v30, -v19, v33, v30
    v_fmac_f32 v31, v18, v33
    v_cvt_pk_bf16_f32 v110, v28, v29
    v_mul_f32 v34, v22, v32
    v_mul_f32 v35, v23, v32
    v_fma_f32 v34, -v23, v33, v34
    v_fmac_f32 v35, v22, v33
    v_cvt_pk_bf16_f32 v63, v30, v31
    s_nop 0
    s_mov_b64 vcc, s[8:9]
    v_cndmask_b32_dpp v49, v48, v97, vcc quad_perm:[1,0,3,2] row_mask:0xf bank_mask:0xf
    v_cndmask_b32_dpp v99, v98, v51, vcc quad_perm:[1,0,3,2] row_mask:0xf bank_mask:0xf
    v_cndmask_b32_dpp v101, v100, v53, vcc quad_perm:[1,0,3,2] row_mask:0xf bank_mask:0xf
    v_cndmask_b32_dpp v55, v54, v103, vcc quad_perm:[1,0,3,2] row_mask:0xf bank_mask:0xf
    v_cndmask_b32_dpp v105, v104, v57, vcc quad_perm:[1,0,3,2] row_mask:0xf bank_mask:0xf
    v_cndmask_b32_dpp v59, v58, v107, vcc quad_perm:[1,0,3,2] row_mask:0xf bank_mask:0xf
    v_cndmask_b32_dpp v61, v60, v109, vcc quad_perm:[1,0,3,2] row_mask:0xf bank_mask:0xf
    v_cndmask_b32_dpp v111, v110, v63, vcc quad_perm:[1,0,3,2] row_mask:0xf bank_mask:0xf
    s_not_b64 vcc, vcc
    v_cndmask_b32_dpp v48, v97, v48, vcc quad_perm:[1,0,3,2] row_mask:0xf bank_mask:0xf
    v_cndmask_b32_dpp v98, v51, v98, vcc quad_perm:[1,0,3,2] row_mask:0xf bank_mask:0xf
    v_cndmask_b32_dpp v100, v53, v100, vcc quad_perm:[1,0,3,2] row_mask:0xf bank_mask:0xf
    v_cndmask_b32_dpp v54, v103, v54, vcc quad_perm:[1,0,3,2] row_mask:0xf bank_mask:0xf
    v_cndmask_b32_dpp v104, v57, v104, vcc quad_perm:[1,0,3,2] row_mask:0xf bank_mask:0xf
    v_cndmask_b32_dpp v58, v107, v58, vcc quad_perm:[1,0,3,2] row_mask:0xf bank_mask:0xf
    v_cndmask_b32_dpp v60, v109, v60, vcc quad_perm:[1,0,3,2] row_mask:0xf bank_mask:0xf
    v_cndmask_b32_dpp v110, v63, v110, vcc quad_perm:[1,0,3,2] row_mask:0xf bank_mask:0xf
    s_mov_b64 vcc, s[10:11]
    v_cndmask_b32_dpp v50, v48, v98, vcc quad_perm:[2,3,0,1] row_mask:0xf bank_mask:0xf
    v_cndmask_b32_dpp v51, v49, v99, vcc quad_perm:[2,3,0,1] row_mask:0xf bank_mask:0xf
    v_cndmask_b32_dpp v102, v100, v54, vcc quad_perm:[2,3,0,1] row_mask:0xf bank_mask:0xf
    v_cndmask_b32_dpp v103, v101, v55, vcc quad_perm:[2,3,0,1] row_mask:0xf bank_mask:0xf
    v_cndmask_b32_dpp v106, v104, v58, vcc quad_perm:[2,3,0,1] row_mask:0xf bank_mask:0xf
    v_cndmask_b32_dpp v107, v105, v59, vcc quad_perm:[2,3,0,1] row_mask:0xf bank_mask:0xf
    v_cndmask_b32_dpp v62, v60, v110, vcc quad_perm:[2,3,0,1] row_mask:0xf bank_mask:0xf
    v_cndmask_b32_dpp v63, v61, v111, vcc quad_perm:[2,3,0,1] row_mask:0xf bank_mask:0xf
    s_not_b64 vcc, vcc
    v_cndmask_b32_dpp v48, v98, v48, vcc quad_perm:[2,3,0,1] row_mask:0xf bank_mask:0xf
    v_cndmask_b32_dpp v49, v99, v49, vcc quad_perm:[2,3,0,1] row_mask:0xf bank_mask:0xf
    v_cndmask_b32_dpp v100, v54, v100, vcc quad_perm:[2,3,0,1] row_mask:0xf bank_mask:0xf
    v_cndmask_b32_dpp v101, v55, v101, vcc quad_perm:[2,3,0,1] row_mask:0xf bank_mask:0xf
    v_cndmask_b32_dpp v104, v58, v104, vcc quad_perm:[2,3,0,1] row_mask:0xf bank_mask:0xf
    v_cndmask_b32_dpp v105, v59, v105, vcc quad_perm:[2,3,0,1] row_mask:0xf bank_mask:0xf
    v_cndmask_b32_dpp v60, v110, v60, vcc quad_perm:[2,3,0,1] row_mask:0xf bank_mask:0xf
    v_cndmask_b32_dpp v61, v111, v61, vcc quad_perm:[2,3,0,1] row_mask:0xf bank_mask:0xf
    s_mov_b64 vcc, s[12:13]
    v_cndmask_b32_dpp v52, v48, v100, vcc row_ror:12 row_mask:0xf bank_mask:0xf
    v_cndmask_b32_dpp v53, v49, v101, vcc row_ror:12 row_mask:0xf bank_mask:0xf
    v_cndmask_b32_dpp v54, v50, v102, vcc row_ror:12 row_mask:0xf bank_mask:0xf
    v_cndmask_b32_dpp v55, v51, v103, vcc row_ror:12 row_mask:0xf bank_mask:0xf
    v_cndmask_b32_dpp v108, v104, v60, vcc row_ror:12 row_mask:0xf bank_mask:0xf
    v_cndmask_b32_dpp v109, v105, v61, vcc row_ror:12 row_mask:0xf bank_mask:0xf
    v_cndmask_b32_dpp v110, v106, v62, vcc row_ror:12 row_mask:0xf bank_mask:0xf
    v_cndmask_b32_dpp v111, v107, v63, vcc row_ror:12 row_mask:0xf bank_mask:0xf
    s_not_b64 vcc, vcc
    v_cndmask_b32_dpp v48, v100, v48, vcc row_ror:4 row_mask:0xf bank_mask:0xf
    v_cndmask_b32_dpp v49, v101, v49, vcc row_ror:4 row_mask:0xf bank_mask:0xf
    v_cndmask_b32_dpp v50, v102, v50, vcc row_ror:4 row_mask:0xf bank_mask:0xf
    v_cndmask_b32_dpp v51, v103, v51, vcc row_ror:4 row_mask:0xf bank_mask:0xf
    v_cndmask_b32_dpp v104, v60, v104, vcc row_ror:4 row_mask:0xf bank_mask:0xf
    v_cndmask_b32_dpp v105, v61, v105, vcc row_ror:4 row_mask:0xf bank_mask:0xf
    v_cndmask_b32_dpp v106, v62, v106, vcc row_ror:4 row_mask:0xf bank_mask:0xf
    v_cndmask_b32_dpp v107, v63, v107, vcc row_ror:4 row_mask:0xf bank_mask:0xf
    s_mov_b64 vcc, s[14:15]
    v_cndmask_b32_dpp v56, v48, v104, vcc row_ror:8 row_mask:0xf bank_mask:0xf
    v_cndmask_b32_dpp v57, v49, v105, vcc row_ror:8 row_mask:0xf bank_mask:0xf
    v_cndmask_b32_dpp v58, v50, v106, vcc row_ror:8 row_mask:0xf bank_mask:0xf
    v_cndmask_b32_dpp v59, v51, v107, vcc row_ror:8 row_mask:0xf bank_mask:0xf
    v_cndmask_b32_dpp v60, v52, v108, vcc row_ror:8 row_mask:0xf bank_mask:0xf
    v_cndmask_b32_dpp v61, v53, v109, vcc row_ror:8 row_mask:0xf bank_mask:0xf
    v_cndmask_b32_dpp v62, v54, v110, vcc row_ror:8 row_mask:0xf bank_mask:0xf
    v_cndmask_b32_dpp v63, v55, v111, vcc row_ror:8 row_mask:0xf bank_mask:0xf
    s_not_b64 vcc, vcc
    v_cndmask_b32_dpp v48, v104, v48, vcc row_ror:8 row_mask:0xf bank_mask:0xf
    v_cndmask_b32_dpp v49, v105, v49, vcc row_ror:8 row_mask:0xf bank_mask:0xf
    v_cndmask_b32_dpp v50, v106, v50, vcc row_ror:8 row_mask:0xf bank_mask:0xf
    v_cndmask_b32_dpp v51, v107, v51, vcc row_ror:8 row_mask:0xf bank_mask:0xf
    v_cndmask_b32_dpp v52, v108, v52, vcc row_ror:8 row_mask:0xf bank_mask:0xf
    v_cndmask_b32_dpp v53, v109, v53, vcc row_ror:8 row_mask:0xf bank_mask:0xf
    v_cndmask_b32_dpp v54, v110, v54, vcc row_ror:8 row_mask:0xf bank_mask:0xf
    v_cndmask_b32_dpp v55, v111, v55, vcc row_ror:8 row_mask:0xf bank_mask:0xf
    v_mul_f32 v36, v16, v32
    v_mul_f32 v37, v17, v32
    v_fma_f32 v36, -v17, v33, v36
    v_fmac_f32 v37, v16, v33
    v_cvt_pk_bf16_f32 v64, v34, v35
    v_mul_f32 v38, v28, v32
    v_mul_f32 v39, v29, v32
    v_fma_f32 v38, -v29, v33, v38
    v_fmac_f32 v39, v28, v33
    v_cvt_pk_bf16_f32 v97, v36, v37
    v_mul_f32 v40, v30, v32
    v_mul_f32 v41, v31, v32
    v_fma_f32 v40, -v31, v33, v40
    v_fmac_f32 v41, v30, v33
    v_cvt_pk_bf16_f32 v98, v38, v39
    v_mul_f32 v42, v34, v32
    v_mul_f32 v43, v35, v32
    v_fma_f32 v42, -v35, v33, v42
    v_fmac_f32 v43, v34, v33
    v_cvt_pk_bf16_f32 v67, v40, v41
    v_mul_f32 v14, v36, v32
    v_mul_f32 v15, v37, v32
    v_fma_f32 v14, -v37, v33, v14
    v_fmac_f32 v15, v36, v33
    v_cvt_pk_bf16_f32 v100, v42, v43
    v_mul_f32 v18, v38, v32
    v_mul_f32 v19, v39, v32
    v_fma_f32 v18, -v39, v33, v18
    v_fmac_f32 v19, v38, v33
    v_cvt_pk_bf16_f32 v69, v14, v15
    v_mul_f32 v22, v40, v32
    v_mul_f32 v23, v41, v32
    v_fma_f32 v22, -v41, v33, v22
    v_fmac_f32 v23, v40, v33
    v_cvt_pk_bf16_f32 v70, v18, v19
    v_mul_f32 v16, v42, v32
    v_mul_f32 v17, v43, v32
    v_fma_f32 v16, -v43, v33, v16
    v_fmac_f32 v17, v42, v33
    v_cvt_pk_bf16_f32 v103, v22, v23
    v_mul_f32 v28, v14, v32
    v_mul_f32 v29, v15, v32
    v_fma_f32 v28, -v15, v33, v28
    v_fmac_f32 v29, v14, v33
    v_cvt_pk_bf16_f32 v104, v16, v17
    v_mul_f32 v30, v18, v32
    v_mul_f32 v31, v19, v32
    v_fma_f32 v30, -v19, v33, v30
    v_fmac_f32 v31, v18, v33
    v_cvt_pk_bf16_f32 v73, v28, v29
    v_mul_f32 v34, v22, v32
    v_mul_f32 v35, v23, v32
    v_fma_f32 v34, -v23, v33, v34
    v_fmac_f32 v35, v22, v33
    v_cvt_pk_bf16_f32 v74, v30, v31
    v_mul_f32 v36, v16, v32
    v_mul_f32 v37, v17, v32
    v_fma_f32 v36, -v17, v33, v36
    v_fmac_f32 v37, v16, v33
    v_cvt_pk_bf16_f32 v107, v34, v35
    v_mul_f32 v38, v28, v32
    v_mul_f32 v39, v29, v32
    v_fma_f32 v38, -v29, v33, v38
    v_fmac_f32 v39, v28, v33
    v_cvt_pk_bf16_f32 v76, v36, v37
    v_mul_f32 v40, v30, v32
    v_mul_f32 v41, v31, v32
    v_fma_f32 v40, -v31, v33, v40
    v_fmac_f32 v41, v30, v33
    v_cvt_pk_bf16_f32 v109, v38, v39
    v_mul_f32 v42, v34, v32
    v_mul_f32 v43, v35, v32
    v_fma_f32 v42, -v35, v33, v42
    v_fmac_f32 v43, v34, v33
    v_cvt_pk_bf16_f32 v110, v40, v41
    v_mul_f32 v14, v26, v20
    v_mul_f32 v15, v27, v20
    v_fma_f32 v14, v27, v21, v14
    v_fma_f32 v15, -v26, v21, v15
    v_cvt_pk_bf16_f32 v79, v42, v43
    s_nop 0
    s_mov_b64 vcc, s[8:9]
    v_cndmask_b32_dpp v65, v64, v97, vcc quad_perm:[1,0,3,2] row_mask:0xf bank_mask:0xf
    v_cndmask_b32_dpp v99, v98, v67, vcc quad_perm:[1,0,3,2] row_mask:0xf bank_mask:0xf
    v_cndmask_b32_dpp v101, v100, v69, vcc quad_perm:[1,0,3,2] row_mask:0xf bank_mask:0xf
    v_cndmask_b32_dpp v71, v70, v103, vcc quad_perm:[1,0,3,2] row_mask:0xf bank_mask:0xf
    v_cndmask_b32_dpp v105, v104, v73, vcc quad_perm:[1,0,3,2] row_mask:0xf bank_mask:0xf
    v_cndmask_b32_dpp v75, v74, v107, vcc quad_perm:[1,0,3,2] row_mask:0xf bank_mask:0xf
    v_cndmask_b32_dpp v77, v76, v109, vcc quad_perm:[1,0,3,2] row_mask:0xf bank_mask:0xf
    v_cndmask_b32_dpp v111, v110, v79, vcc quad_perm:[1,0,3,2] row_mask:0xf bank_mask:0xf
    s_not_b64 vcc, vcc
    v_cndmask_b32_dpp v64, v97, v64, vcc quad_perm:[1,0,3,2] row_mask:0xf bank_mask:0xf
    v_cndmask_b32_dpp v98, v67, v98, vcc quad_perm:[1,0,3,2] row_mask:0xf bank_mask:0xf
    v_cndmask_b32_dpp v100, v69, v100, vcc quad_perm:[1,0,3,2] row_mask:0xf bank_mask:0xf
    v_cndmask_b32_dpp v70, v103, v70, vcc quad_perm:[1,0,3,2] row_mask:0xf bank_mask:0xf
    v_cndmask_b32_dpp v104, v73, v104, vcc quad_perm:[1,0,3,2] row_mask:0xf bank_mask:0xf
    v_cndmask_b32_dpp v74, v107, v74, vcc quad_perm:[1,0,3,2] row_mask:0xf bank_mask:0xf
    v_cndmask_b32_dpp v76, v109, v76, vcc quad_perm:[1,0,3,2] row_mask:0xf bank_mask:0xf
    v_cndmask_b32_dpp v110, v79, v110, vcc quad_perm:[1,0,3,2] row_mask:0xf bank_mask:0xf
    s_mov_b64 vcc, s[10:11]
    v_cndmask_b32_dpp v66, v64, v98, vcc quad_perm:[2,3,0,1] row_mask:0xf bank_mask:0xf
    v_cndmask_b32_dpp v67, v65, v99, vcc quad_perm:[2,3,0,1] row_mask:0xf bank_mask:0xf
    v_cndmask_b32_dpp v102, v100, v70, vcc quad_perm:[2,3,0,1] row_mask:0xf bank_mask:0xf
    v_cndmask_b32_dpp v103, v101, v71, vcc quad_perm:[2,3,0,1] row_mask:0xf bank_mask:0xf
    v_cndmask_b32_dpp v106, v104, v74, vcc quad_perm:[2,3,0,1] row_mask:0xf bank_mask:0xf
    v_cndmask_b32_dpp v107, v105, v75, vcc quad_perm:[2,3,0,1] row_mask:0xf bank_mask:0xf
    v_cndmask_b32_dpp v78, v76, v110, vcc quad_perm:[2,3,0,1] row_mask:0xf bank_mask:0xf
    v_cndmask_b32_dpp v79, v77, v111, vcc quad_perm:[2,3,0,1] row_mask:0xf bank_mask:0xf
    s_not_b64 vcc, vcc
    v_cndmask_b32_dpp v64, v98, v64, vcc quad_perm:[2,3,0,1] row_mask:0xf bank_mask:0xf
    v_cndmask_b32_dpp v65, v99, v65, vcc quad_perm:[2,3,0,1] row_mask:0xf bank_mask:0xf
    v_cndmask_b32_dpp v100, v70, v100, vcc quad_perm:[2,3,0,1] row_mask:0xf bank_mask:0xf
    v_cndmask_b32_dpp v101, v71, v101, vcc quad_perm:[2,3,0,1] row_mask:0xf bank_mask:0xf
    v_cndmask_b32_dpp v104, v74, v104, vcc quad_perm:[2,3,0,1] row_mask:0xf bank_mask:0xf
    v_cndmask_b32_dpp v105, v75, v105, vcc quad_perm:[2,3,0,1] row_mask:0xf bank_mask:0xf
    v_cndmask_b32_dpp v76, v110, v76, vcc quad_perm:[2,3,0,1] row_mask:0xf bank_mask:0xf
    v_cndmask_b32_dpp v77, v111, v77, vcc quad_perm:[2,3,0,1] row_mask:0xf bank_mask:0xf
    s_mov_b64 vcc, s[12:13]
    v_cndmask_b32_dpp v68, v64, v100, vcc row_ror:12 row_mask:0xf bank_mask:0xf
    v_cndmask_b32_dpp v69, v65, v101, vcc row_ror:12 row_mask:0xf bank_mask:0xf
    v_cndmask_b32_dpp v70, v66, v102, vcc row_ror:12 row_mask:0xf bank_mask:0xf
    v_cndmask_b32_dpp v71, v67, v103, vcc row_ror:12 row_mask:0xf bank_mask:0xf
    v_cndmask_b32_dpp v108, v104, v76, vcc row_ror:12 row_mask:0xf bank_mask:0xf
    v_cndmask_b32_dpp v109, v105, v77, vcc row_ror:12 row_mask:0xf bank_mask:0xf
    v_cndmask_b32_dpp v110, v106, v78, vcc row_ror:12 row_mask:0xf bank_mask:0xf
    v_cndmask_b32_dpp v111, v107, v79, vcc row_ror:12 row_mask:0xf bank_mask:0xf
    s_not_b64 vcc, vcc
    v_cndmask_b32_dpp v64, v100, v64, vcc row_ror:4 row_mask:0xf bank_mask:0xf
    v_cndmask_b32_dpp v65, v101, v65, vcc row_ror:4 row_mask:0xf bank_mask:0xf
    v_cndmask_b32_dpp v66, v102, v66, vcc row_ror:4 row_mask:0xf bank_mask:0xf
    v_cndmask_b32_dpp v67, v103, v67, vcc row_ror:4 row_mask:0xf bank_mask:0xf
    v_cndmask_b32_dpp v104, v76, v104, vcc row_ror:4 row_mask:0xf bank_mask:0xf
    v_cndmask_b32_dpp v105, v77, v105, vcc row_ror:4 row_mask:0xf bank_mask:0xf
    v_cndmask_b32_dpp v106, v78, v106, vcc row_ror:4 row_mask:0xf bank_mask:0xf
    v_cndmask_b32_dpp v107, v79, v107, vcc row_ror:4 row_mask:0xf bank_mask:0xf
    s_mov_b64 vcc, s[14:15]
    v_cndmask_b32_dpp v72, v64, v104, vcc row_ror:8 row_mask:0xf bank_mask:0xf
    v_cndmask_b32_dpp v73, v65, v105, vcc row_ror:8 row_mask:0xf bank_mask:0xf
    v_cndmask_b32_dpp v74, v66, v106, vcc row_ror:8 row_mask:0xf bank_mask:0xf
    v_cndmask_b32_dpp v75, v67, v107, vcc row_ror:8 row_mask:0xf bank_mask:0xf
    v_cndmask_b32_dpp v76, v68, v108, vcc row_ror:8 row_mask:0xf bank_mask:0xf
    v_cndmask_b32_dpp v77, v69, v109, vcc row_ror:8 row_mask:0xf bank_mask:0xf
    v_cndmask_b32_dpp v78, v70, v110, vcc row_ror:8 row_mask:0xf bank_mask:0xf
    v_cndmask_b32_dpp v79, v71, v111, vcc row_ror:8 row_mask:0xf bank_mask:0xf
    s_not_b64 vcc, vcc
    v_cndmask_b32_dpp v64, v104, v64, vcc row_ror:8 row_mask:0xf bank_mask:0xf
    v_cndmask_b32_dpp v65, v105, v65, vcc row_ror:8 row_mask:0xf bank_mask:0xf
    v_cndmask_b32_dpp v66, v106, v66, vcc row_ror:8 row_mask:0xf bank_mask:0xf
    v_cndmask_b32_dpp v67, v107, v67, vcc row_ror:8 row_mask:0xf bank_mask:0xf
    v_cndmask_b32_dpp v68, v108, v68, vcc row_ror:8 row_mask:0xf bank_mask:0xf
    v_cndmask_b32_dpp v69, v109, v69, vcc row_ror:8 row_mask:0xf bank_mask:0xf
    v_cndmask_b32_dpp v70, v110, v70, vcc row_ror:8 row_mask:0xf bank_mask:0xf
    v_cndmask_b32_dpp v71, v111, v71, vcc row_ror:8 row_mask:0xf bank_mask:0xf
    v_mul_f32 v18, v26, v24
    v_mul_f32 v19, v27, v24
    v_fma_f32 v18, v27, v25, v18
    v_fma_f32 v19, -v26, v25, v19
    v_cvt_pk_bf16_f32 v100, v26, v27
    v_cvt_pk_bf16_f32 v85, v14, v15
    v_mul_f32 v22, v14, v20
    v_mul_f32 v23, v15, v20
    v_fma_f32 v22, v15, v21, v22
    v_fma_f32 v23, -v14, v21, v23
    v_cvt_pk_bf16_f32 v80, v18, v19
    v_mul_f32 v16, v18, v24
    v_mul_f32 v17, v19, v24
    v_fma_f32 v16, v19, v25, v16
    v_fma_f32 v17, -v18, v25, v17
    v_cvt_pk_bf16_f32 v86, v22, v23
    v_mul_f32 v28, v22, v20
    v_mul_f32 v29, v23, v20
    v_fma_f32 v28, v23, v21, v28
    v_fma_f32 v29, -v22, v21, v29
    v_cvt_pk_bf16_f32 v97, v16, v17
    v_mul_f32 v30, v16, v24
    v_mul_f32 v31, v17, v24
    v_fma_f32 v30, v17, v25, v30
    v_fma_f32 v31, -v16, v25, v31
    v_cvt_pk_bf16_f32 v103, v28, v29
    v_mul_f32 v34, v28, v20
    v_mul_f32 v35, v29, v20
    v_fma_f32 v34, v29, v21, v34
    v_fma_f32 v35, -v28, v21, v35
    v_cvt_pk_bf16_f32 v98, v30, v31
    v_mul_f32 v36, v30, v24
    v_mul_f32 v37, v31, v24
    v_fma_f32 v36, v31, v25, v36
    v_fma_f32 v37, -v30, v25, v37
    v_cvt_pk_bf16_f32 v104, v34, v35
    v_mul_f32 v38, v34, v20
    v_mul_f32 v39, v35, v20
    v_fma_f32 v38, v35, v21, v38
    v_fma_f32 v39, -v34, v21, v39
    v_cvt_pk_bf16_f32 v83, v36, v37
    v_mul_f32 v40, v22, v24
    v_mul_f32 v41, v23, v24
    v_fma_f32 v40, v23, v25, v40
    v_fma_f32 v41, -v22, v25, v41
    v_cvt_pk_bf16_f32 v89, v38, v39
    v_mul_f32 v42, v38, v20
    v_mul_f32 v43, v39, v20
    v_fma_f32 v42, v39, v21, v42
    v_fma_f32 v43, -v38, v21, v43
    v_cvt_pk_bf16_f32 v92, v40, v41
    v_mul_f32 v32, v34, v24
    v_mul_f32 v33, v35, v24
    v_fma_f32 v32, v35, v25, v32
    v_fma_f32 v33, -v34, v25, v33
    v_cvt_pk_bf16_f32 v90, v42, v43
    v_mul_f32 v18, v42, v20
    v_mul_f32 v19, v43, v20
    v_fma_f32 v18, v43, v21, v18
    v_fma_f32 v19, -v42, v21, v19
    v_cvt_pk_bf16_f32 v109, v32, v33
    v_mul_f32 v14, v42, v24
    v_mul_f32 v15, v43, v24
    v_fma_f32 v14, v43, v25, v14
    v_fma_f32 v15, -v42, v25, v15
    v_cvt_pk_bf16_f32 v107, v18, v19
    v_mul_f32 v16, v32, v24
    v_mul_f32 v17, v33, v24
    v_fma_f32 v16, v33, v25, v16
    v_fma_f32 v17, -v32, v25, v17
    v_cvt_pk_bf16_f32 v110, v14, v15
    v_mul_f32 v30, v36, v24
    v_mul_f32 v31, v37, v24
    v_fma_f32 v30, v37, v25, v30
    v_fma_f32 v31, -v36, v25, v31
    v_cvt_pk_bf16_f32 v95, v16, v17
    s_nop 0
    s_mov_b64 vcc, s[8:9]
    v_cndmask_b32_dpp v81, v80, v97, vcc quad_perm:[1,0,3,2] row_mask:0xf bank_mask:0xf
    v_cndmask_b32_dpp v99, v98, v83, vcc quad_perm:[1,0,3,2] row_mask:0xf bank_mask:0xf
    v_cndmask_b32_dpp v101, v100, v85, vcc quad_perm:[1,0,3,2] row_mask:0xf bank_mask:0xf
    v_cndmask_b32_dpp v87, v86, v103, vcc quad_perm:[1,0,3,2] row_mask:0xf bank_mask:0xf
    v_cndmask_b32_dpp v105, v104, v89, vcc quad_perm:[1,0,3,2] row_mask:0xf bank_mask:0xf
    v_cndmask_b32_dpp v91, v90, v107, vcc quad_perm:[1,0,3,2] row_mask:0xf bank_mask:0xf
    v_cndmask_b32_dpp v93, v92, v109, vcc quad_perm:[1,0,3,2] row_mask:0xf bank_mask:0xf
    v_cndmask_b32_dpp v111, v110, v95, vcc quad_perm:[1,0,3,2] row_mask:0xf bank_mask:0xf
    s_not_b64 vcc, vcc
    v_cndmask_b32_dpp v80, v97, v80, vcc quad_perm:[1,0,3,2] row_mask:0xf bank_mask:0xf
    v_cndmask_b32_dpp v98, v83, v98, vcc quad_perm:[1,0,3,2] row_mask:0xf bank_mask:0xf
    v_cndmask_b32_dpp v100, v85, v100, vcc quad_perm:[1,0,3,2] row_mask:0xf bank_mask:0xf
    v_cndmask_b32_dpp v86, v103, v86, vcc quad_perm:[1,0,3,2] row_mask:0xf bank_mask:0xf
    v_cndmask_b32_dpp v104, v89, v104, vcc quad_perm:[1,0,3,2] row_mask:0xf bank_mask:0xf
    v_cndmask_b32_dpp v90, v107, v90, vcc quad_perm:[1,0,3,2] row_mask:0xf bank_mask:0xf
    v_cndmask_b32_dpp v92, v109, v92, vcc quad_perm:[1,0,3,2] row_mask:0xf bank_mask:0xf
    v_cndmask_b32_dpp v110, v95, v110, vcc quad_perm:[1,0,3,2] row_mask:0xf bank_mask:0xf
    s_mov_b64 vcc, s[10:11]
    v_cndmask_b32_dpp v82, v80, v98, vcc quad_perm:[2,3,0,1] row_mask:0xf bank_mask:0xf
    v_cndmask_b32_dpp v83, v81, v99, vcc quad_perm:[2,3,0,1] row_mask:0xf bank_mask:0xf
    v_cndmask_b32_dpp v102, v100, v86, vcc quad_perm:[2,3,0,1] row_mask:0xf bank_mask:0xf
    v_cndmask_b32_dpp v103, v101, v87, vcc quad_perm:[2,3,0,1] row_mask:0xf bank_mask:0xf
    v_cndmask_b32_dpp v106, v104, v90, vcc quad_perm:[2,3,0,1] row_mask:0xf bank_mask:0xf
    v_cndmask_b32_dpp v107, v105, v91, vcc quad_perm:[2,3,0,1] row_mask:0xf bank_mask:0xf
    v_cndmask_b32_dpp v94, v92, v110, vcc quad_perm:[2,3,0,1] row_mask:0xf bank_mask:0xf
    v_cndmask_b32_dpp v95, v93, v111, vcc quad_perm:[2,3,0,1] row_mask:0xf bank_mask:0xf
    s_not_b64 vcc, vcc
    v_cndmask_b32_dpp v80, v98, v80, vcc quad_perm:[2,3,0,1] row_mask:0xf bank_mask:0xf
    v_cndmask_b32_dpp v81, v99, v81, vcc quad_perm:[2,3,0,1] row_mask:0xf bank_mask:0xf
    v_cndmask_b32_dpp v100, v86, v100, vcc quad_perm:[2,3,0,1] row_mask:0xf bank_mask:0xf
    v_cndmask_b32_dpp v101, v87, v101, vcc quad_perm:[2,3,0,1] row_mask:0xf bank_mask:0xf
    v_cndmask_b32_dpp v104, v90, v104, vcc quad_perm:[2,3,0,1] row_mask:0xf bank_mask:0xf
    v_cndmask_b32_dpp v105, v91, v105, vcc quad_perm:[2,3,0,1] row_mask:0xf bank_mask:0xf
    v_cndmask_b32_dpp v92, v110, v92, vcc quad_perm:[2,3,0,1] row_mask:0xf bank_mask:0xf
    v_cndmask_b32_dpp v93, v111, v93, vcc quad_perm:[2,3,0,1] row_mask:0xf bank_mask:0xf
    s_mov_b64 vcc, s[12:13]
    v_cndmask_b32_dpp v84, v80, v100, vcc row_ror:12 row_mask:0xf bank_mask:0xf
    v_cndmask_b32_dpp v85, v81, v101, vcc row_ror:12 row_mask:0xf bank_mask:0xf
    v_cndmask_b32_dpp v86, v82, v102, vcc row_ror:12 row_mask:0xf bank_mask:0xf
    v_cndmask_b32_dpp v87, v83, v103, vcc row_ror:12 row_mask:0xf bank_mask:0xf
    v_cndmask_b32_dpp v108, v104, v92, vcc row_ror:12 row_mask:0xf bank_mask:0xf
    v_cndmask_b32_dpp v109, v105, v93, vcc row_ror:12 row_mask:0xf bank_mask:0xf
    v_cndmask_b32_dpp v110, v106, v94, vcc row_ror:12 row_mask:0xf bank_mask:0xf
    v_cndmask_b32_dpp v111, v107, v95, vcc row_ror:12 row_mask:0xf bank_mask:0xf
    s_not_b64 vcc, vcc
    v_cndmask_b32_dpp v80, v100, v80, vcc row_ror:4 row_mask:0xf bank_mask:0xf
    v_cndmask_b32_dpp v81, v101, v81, vcc row_ror:4 row_mask:0xf bank_mask:0xf
    v_cndmask_b32_dpp v82, v102, v82, vcc row_ror:4 row_mask:0xf bank_mask:0xf
    v_cndmask_b32_dpp v83, v103, v83, vcc row_ror:4 row_mask:0xf bank_mask:0xf
    v_cndmask_b32_dpp v104, v92, v104, vcc row_ror:4 row_mask:0xf bank_mask:0xf
    v_cndmask_b32_dpp v105, v93, v105, vcc row_ror:4 row_mask:0xf bank_mask:0xf
    v_cndmask_b32_dpp v106, v94, v106, vcc row_ror:4 row_mask:0xf bank_mask:0xf
    v_cndmask_b32_dpp v107, v95, v107, vcc row_ror:4 row_mask:0xf bank_mask:0xf
    s_mov_b64 vcc, s[14:15]
    v_cndmask_b32_dpp v88, v80, v104, vcc row_ror:8 row_mask:0xf bank_mask:0xf
    v_cndmask_b32_dpp v89, v81, v105, vcc row_ror:8 row_mask:0xf bank_mask:0xf
    v_cndmask_b32_dpp v90, v82, v106, vcc row_ror:8 row_mask:0xf bank_mask:0xf
    v_cndmask_b32_dpp v91, v83, v107, vcc row_ror:8 row_mask:0xf bank_mask:0xf
    v_cndmask_b32_dpp v92, v84, v108, vcc row_ror:8 row_mask:0xf bank_mask:0xf
    v_cndmask_b32_dpp v93, v85, v109, vcc row_ror:8 row_mask:0xf bank_mask:0xf
    v_cndmask_b32_dpp v94, v86, v110, vcc row_ror:8 row_mask:0xf bank_mask:0xf
    v_cndmask_b32_dpp v95, v87, v111, vcc row_ror:8 row_mask:0xf bank_mask:0xf
    s_not_b64 vcc, vcc
    v_cndmask_b32_dpp v80, v104, v80, vcc row_ror:8 row_mask:0xf bank_mask:0xf
    v_cndmask_b32_dpp v81, v105, v81, vcc row_ror:8 row_mask:0xf bank_mask:0xf
    v_cndmask_b32_dpp v82, v106, v82, vcc row_ror:8 row_mask:0xf bank_mask:0xf
    v_cndmask_b32_dpp v83, v107, v83, vcc row_ror:8 row_mask:0xf bank_mask:0xf
    v_cndmask_b32_dpp v84, v108, v84, vcc row_ror:8 row_mask:0xf bank_mask:0xf
    v_cndmask_b32_dpp v85, v109, v85, vcc row_ror:8 row_mask:0xf bank_mask:0xf
    v_cndmask_b32_dpp v86, v110, v86, vcc row_ror:8 row_mask:0xf bank_mask:0xf
    v_cndmask_b32_dpp v87, v111, v87, vcc row_ror:8 row_mask:0xf bank_mask:0xf
    s_nop 1
    v_mfma_f32_16x16x32_bf16 v[112:115], v[80:83], v[48:51], 0
    v_mfma_f32_16x16x32_bf16 v[116:119], v[80:83], v[64:67], 0
    v_mfma_f32_16x16x32_bf16 v[112:115], v[84:87], v[52:55], v[112:115]
    v_mfma_f32_16x16x32_bf16 v[116:119], v[84:87], v[68:71], v[116:119]
    v_mfma_f32_16x16x32_bf16 v[112:115], v[88:91], v[56:59], v[112:115]
    v_mfma_f32_16x16x32_bf16 v[116:119], v[88:91], v[72:75], v[116:119]
    v_mfma_f32_16x16x32_bf16 v[112:115], v[92:95], v[60:63], v[112:115]
    v_mfma_f32_16x16x32_bf16 v[116:119], v[92:95], v[76:79], v[116:119]
    v_mul_f32 v28, v30, v24
    v_mul_f32 v29, v31, v24
    v_fma_f32 v28, v31, v25, v28
    v_fma_f32 v29, -v30, v25, v29
    v_mul_f32 v22, v16, v24
    v_mul_f32 v23, v17, v24
    v_fma_f32 v22, v17, v25, v22
    v_fma_f32 v23, -v16, v25, v23
    v_mul_f32 v34, v28, v24
    v_mul_f32 v35, v29, v24
    v_fma_f32 v34, v29, v25, v34
    v_fma_f32 v35, -v28, v25, v35
    v_mul_f32 v38, v34, v24
    v_mul_f32 v39, v35, v24
    v_fma_f32 v38, v35, v25, v38
    v_fma_f32 v39, -v34, v25, v39
    v_cvt_pk_bf16_f32 v80, v30, v31
    v_cvt_pk_bf16_f32 v97, v28, v29
    v_cvt_pk_bf16_f32 v108, v22, v23
    v_cvt_pk_bf16_f32 v98, v34, v35
    v_cvt_pk_bf16_f32 v83, v38, v39
    s_nop 0
    s_mov_b64 vcc, s[8:9]
    v_cndmask_b32_dpp v81, v80, v97, vcc quad_perm:[1,0,3,2] row_mask:0xf bank_mask:0xf
    v_cndmask_b32_dpp v99, v98, v83, vcc quad_perm:[1,0,3,2] row_mask:0xf bank_mask:0xf
    v_mov_b32_dpp v109, v108 quad_perm:[1,0,3,2] row_mask:0xf bank_mask:0xf
    s_not_b64 vcc, vcc
    v_cndmask_b32_dpp v80, v97, v80, vcc quad_perm:[1,0,3,2] row_mask:0xf bank_mask:0xf
    v_cndmask_b32_dpp v98, v83, v98, vcc quad_perm:[1,0,3,2] row_mask:0xf bank_mask:0xf
    s_mov_b64 vcc, s[10:11]
    v_cndmask_b32_dpp v82, v80, v98, vcc quad_perm:[2,3,0,1] row_mask:0xf bank_mask:0xf
    v_cndmask_b32_dpp v83, v81, v99, vcc quad_perm:[2,3,0,1] row_mask:0xf bank_mask:0xf
    v_mov_b32_dpp v110, v108 quad_perm:[2,3,0,1] row_mask:0xf bank_mask:0xf
    v_mov_b32_dpp v111, v109 quad_perm:[2,3,0,1] row_mask:0xf bank_mask:0xf
    s_not_b64 vcc, vcc
    v_cndmask_b32_dpp v80, v98, v80, vcc quad_perm:[2,3,0,1] row_mask:0xf bank_mask:0xf
    v_cndmask_b32_dpp v81, v99, v81, vcc quad_perm:[2,3,0,1] row_mask:0xf bank_mask:0xf
    s_nop 0
    v_mov_b32_dpp v84, v80 row_ror:12 row_mask:0xf bank_mask:0xf
    v_mov_b32_dpp v85, v81 row_ror:12 row_mask:0xf bank_mask:0xf
    v_mov_b32_dpp v86, v82 row_ror:12 row_mask:0xf bank_mask:0xf
    v_mov_b32_dpp v87, v83 row_ror:12 row_mask:0xf bank_mask:0xf
    v_mov_b32_dpp v104, v108 row_ror:4 row_mask:0xf bank_mask:0xf
    v_mov_b32_dpp v105, v109 row_ror:4 row_mask:0xf bank_mask:0xf
    v_mov_b32_dpp v106, v110 row_ror:4 row_mask:0xf bank_mask:0xf
    v_mov_b32_dpp v107, v111 row_ror:4 row_mask:0xf bank_mask:0xf
    s_mov_b64 vcc, s[14:15]
    v_cndmask_b32_dpp v88, v80, v104, vcc row_ror:8 row_mask:0xf bank_mask:0xf
    v_cndmask_b32_dpp v89, v81, v105, vcc row_ror:8 row_mask:0xf bank_mask:0xf
    v_cndmask_b32_dpp v90, v82, v106, vcc row_ror:8 row_mask:0xf bank_mask:0xf
    v_cndmask_b32_dpp v91, v83, v107, vcc row_ror:8 row_mask:0xf bank_mask:0xf
    v_cndmask_b32_dpp v92, v84, v108, vcc row_ror:8 row_mask:0xf bank_mask:0xf
    v_cndmask_b32_dpp v93, v85, v109, vcc row_ror:8 row_mask:0xf bank_mask:0xf
    v_cndmask_b32_dpp v94, v86, v110, vcc row_ror:8 row_mask:0xf bank_mask:0xf
    v_cndmask_b32_dpp v95, v87, v111, vcc row_ror:8 row_mask:0xf bank_mask:0xf
    s_not_b64 vcc, vcc
    v_cndmask_b32_dpp v80, v104, v80, vcc row_ror:8 row_mask:0xf bank_mask:0xf
    v_cndmask_b32_dpp v81, v105, v81, vcc row_ror:8 row_mask:0xf bank_mask:0xf
    v_cndmask_b32_dpp v82, v106, v82, vcc row_ror:8 row_mask:0xf bank_mask:0xf
    v_cndmask_b32_dpp v83, v107, v83, vcc row_ror:8 row_mask:0xf bank_mask:0xf
    v_cndmask_b32_dpp v84, v108, v84, vcc row_ror:8 row_mask:0xf bank_mask:0xf
    v_cndmask_b32_dpp v85, v109, v85, vcc row_ror:8 row_mask:0xf bank_mask:0xf
    v_cndmask_b32_dpp v86, v110, v86, vcc row_ror:8 row_mask:0xf bank_mask:0xf
    v_cndmask_b32_dpp v87, v111, v87, vcc row_ror:8 row_mask:0xf bank_mask:0xf
    s_nop 1
    v_mfma_f32_16x16x32_bf16 v[120:123], v[80:83], v[48:51], 0
    v_mfma_f32_16x16x32_bf16 v[124:127], v[80:83], v[64:67], 0
    v_mfma_f32_16x16x32_bf16 v[120:123], v[84:87], v[52:55], v[120:123]
    v_mfma_f32_16x16x32_bf16 v[124:127], v[84:87], v[68:71], v[124:127]
    v_mfma_f32_16x16x32_bf16 v[120:123], v[88:91], v[56:59], v[120:123]
    v_mfma_f32_16x16x32_bf16 v[124:127], v[88:91], v[72:75], v[124:127]
    v_mfma_f32_16x16x32_bf16 v[120:123], v[92:95], v[60:63], v[120:123]
    v_mfma_f32_16x16x32_bf16 v[124:127], v[92:95], v[76:79], v[124:127]
    v_accvgpr_read_b32 v96, a0
    v_accvgpr_read_b32 v97, a1
    v_accvgpr_read_b32 v98, a2
    v_accvgpr_read_b32 v99, a3
    v_accvgpr_read_b32 v100, a4
    v_accvgpr_read_b32 v101, a5
    v_mul_f32 v96, v13, v96
    v_mul_f32 v97, v13, v97
    v_mul_f32 v96, 1069066811, v96
    v_mul_f32 v97, 0.15915494, v97
    v_mul_f32 v98, v13, v98
    v_mul_f32 v99, v13, v99
    v_mul_f32 v15, 1090519040, v97
    v_mul_f32 v14, 1090519040, v96
    v_fract_f32 v15, v15
    v_exp_f32 v14, v14
    v_cos_f32 v16, v15
    v_sin_f32 v17, v15
    s_nop 0
    v_mul_f32 v16, v16, v14
    v_mul_f32 v17, v17, v14
    v_fract_f32 v19, v97
    v_exp_f32 v18, v96
    v_cos_f32 v20, v19
    v_sin_f32 v21, v19
    s_nop 0
    v_mul_f32 v20, v20, v18
    v_mul_f32 v21, v21, v18
    v_mul_f32 v23, 1132462080, v97
    v_mul_f32 v22, 1132462080, v96
    v_fract_f32 v23, v23
    v_exp_f32 v22, v22
    v_cos_f32 v24, v23
    v_sin_f32 v25, v23
    s_nop 0
    v_mul_f32 v24, v24, v22
    v_mul_f32 v25, v25, v22
    v_mul_f32 v26, v100, v98
    v_mul_f32 v27, v101, v98
    v_fma_f32 v26, -v101, v99, v26
    v_fmac_f32 v27, v100, v99
    v_xor_b32 v27, 0x80000000, v27
    v_mul_f32 v28, v16, v16
    v_mul_f32 v29, v17, v16
    v_fma_f32 v28, -v17, v17, v28
    v_fmac_f32 v29, v16, v17
    v_cvt_pk_bf16_f32 v48, 1.0, 0
    v_cvt_pk_bf16_f32 v97, v16, v17
    v_mul_f32 v30, v28, v16
    v_mul_f32 v31, v29, v16
    v_fma_f32 v30, -v29, v17, v30
    v_fmac_f32 v31, v28, v17
    v_cvt_pk_bf16_f32 v98, v28, v29
    v_mul_f32 v32, v28, v28
    v_mul_f32 v33, v29, v28
    v_fma_f32 v32, -v29, v29, v32
    v_fmac_f32 v33, v28, v29
    v_cvt_pk_bf16_f32 v51, v30, v31
    v_mul_f32 v34, v16, v32
    v_mul_f32 v35, v17, v32
    v_fma_f32 v34, -v17, v33, v34
    v_fmac_f32 v35, v16, v33
    v_cvt_pk_bf16_f32 v100, v32, v33
    v_mul_f32 v36, v28, v32
    v_mul_f32 v37, v29, v32
    v_fma_f32 v36, -v29, v33, v36
    v_fmac_f32 v37, v28, v33
    v_cvt_pk_bf16_f32 v53, v34, v35
    v_mul_f32 v38, v30, v32
    v_mul_f32 v39, v31, v32
    v_fma_f32 v38, -v31, v33, v38
    v_fmac_f32 v39, v30, v33
    v_cvt_pk_bf16_f32 v54, v36, v37
    v_mul_f32 v40, v32, v32
    v_mul_f32 v41, v33, v32
    v_fma_f32 v40, -v33, v33, v40
    v_fmac_f32 v41, v32, v33
    v_cvt_pk_bf16_f32 v103, v38, v39
    v_mul_f32 v42, v34, v32
    v_mul_f32 v43, v35, v32
    v_fma_f32 v42, -v35, v33, v42
    v_fmac_f32 v43, v34, v33
    v_cvt_pk_bf16_f32 v104, v40, v41
    v_mul_f32 v14, v36, v32
    v_mul_f32 v15, v37, v32
    v_fma_f32 v14, -v37, v33, v14
    v_fmac_f32 v15, v36, v33
    v_cvt_pk_bf16_f32 v57, v42, v43
    v_mul_f32 v18, v38, v32
    v_mul_f32 v19, v39, v32
    v_fma_f32 v18, -v39, v33, v18
    v_fmac_f32 v19, v38, v33
    v_cvt_pk_bf16_f32 v58, v14, v15
    v_mul_f32 v22, v40, v32
    v_mul_f32 v23, v41, v32
    v_fma_f32 v22, -v41, v33, v22
    v_fmac_f32 v23, v40, v33
    v_cvt_pk_bf16_f32 v107, v18, v19
    v_mul_f32 v16, v42, v32
    v_mul_f32 v17, v43, v32
    v_fma_f32 v16, -v43, v33, v16
    v_fmac_f32 v17, v42, v33
    v_cvt_pk_bf16_f32 v60, v22, v23
    v_mul_f32 v28, v14, v32
    v_mul_f32 v29, v15, v32
    v_fma_f32 v28, -v15, v33, v28
    v_fmac_f32 v29, v14, v33
    v_cvt_pk_bf16_f32 v109, v16, v17
    v_mul_f32 v30, v18, v32
    v_mul_f32 v31, v19, v32
    v_fma_f32 v30, -v19, v33, v30
    v_fmac_f32 v31, v18, v33
    v_cvt_pk_bf16_f32 v110, v28, v29
    v_mul_f32 v34, v22, v32
    v_mul_f32 v35, v23, v32
    v_fma_f32 v34, -v23, v33, v34
    v_fmac_f32 v35, v22, v33
    v_cvt_pk_bf16_f32 v63, v30, v31
    s_nop 0
    s_mov_b64 vcc, s[8:9]
    v_cndmask_b32_dpp v49, v48, v97, vcc quad_perm:[1,0,3,2] row_mask:0xf bank_mask:0xf
    v_cndmask_b32_dpp v99, v98, v51, vcc quad_perm:[1,0,3,2] row_mask:0xf bank_mask:0xf
    v_cndmask_b32_dpp v101, v100, v53, vcc quad_perm:[1,0,3,2] row_mask:0xf bank_mask:0xf
    v_cndmask_b32_dpp v55, v54, v103, vcc quad_perm:[1,0,3,2] row_mask:0xf bank_mask:0xf
    v_cndmask_b32_dpp v105, v104, v57, vcc quad_perm:[1,0,3,2] row_mask:0xf bank_mask:0xf
    v_cndmask_b32_dpp v59, v58, v107, vcc quad_perm:[1,0,3,2] row_mask:0xf bank_mask:0xf
    v_cndmask_b32_dpp v61, v60, v109, vcc quad_perm:[1,0,3,2] row_mask:0xf bank_mask:0xf
    v_cndmask_b32_dpp v111, v110, v63, vcc quad_perm:[1,0,3,2] row_mask:0xf bank_mask:0xf
    s_not_b64 vcc, vcc
    v_cndmask_b32_dpp v48, v97, v48, vcc quad_perm:[1,0,3,2] row_mask:0xf bank_mask:0xf
    v_cndmask_b32_dpp v98, v51, v98, vcc quad_perm:[1,0,3,2] row_mask:0xf bank_mask:0xf
    v_cndmask_b32_dpp v100, v53, v100, vcc quad_perm:[1,0,3,2] row_mask:0xf bank_mask:0xf
    v_cndmask_b32_dpp v54, v103, v54, vcc quad_perm:[1,0,3,2] row_mask:0xf bank_mask:0xf
    v_cndmask_b32_dpp v104, v57, v104, vcc quad_perm:[1,0,3,2] row_mask:0xf bank_mask:0xf
    v_cndmask_b32_dpp v58, v107, v58, vcc quad_perm:[1,0,3,2] row_mask:0xf bank_mask:0xf
    v_cndmask_b32_dpp v60, v109, v60, vcc quad_perm:[1,0,3,2] row_mask:0xf bank_mask:0xf
    v_cndmask_b32_dpp v110, v63, v110, vcc quad_perm:[1,0,3,2] row_mask:0xf bank_mask:0xf
    s_mov_b64 vcc, s[10:11]
    v_cndmask_b32_dpp v50, v48, v98, vcc quad_perm:[2,3,0,1] row_mask:0xf bank_mask:0xf
    v_cndmask_b32_dpp v51, v49, v99, vcc quad_perm:[2,3,0,1] row_mask:0xf bank_mask:0xf
    v_cndmask_b32_dpp v102, v100, v54, vcc quad_perm:[2,3,0,1] row_mask:0xf bank_mask:0xf
    v_cndmask_b32_dpp v103, v101, v55, vcc quad_perm:[2,3,0,1] row_mask:0xf bank_mask:0xf
    v_cndmask_b32_dpp v106, v104, v58, vcc quad_perm:[2,3,0,1] row_mask:0xf bank_mask:0xf
    v_cndmask_b32_dpp v107, v105, v59, vcc quad_perm:[2,3,0,1] row_mask:0xf bank_mask:0xf
    v_cndmask_b32_dpp v62, v60, v110, vcc quad_perm:[2,3,0,1] row_mask:0xf bank_mask:0xf
    v_cndmask_b32_dpp v63, v61, v111, vcc quad_perm:[2,3,0,1] row_mask:0xf bank_mask:0xf
    s_not_b64 vcc, vcc
    v_cndmask_b32_dpp v48, v98, v48, vcc quad_perm:[2,3,0,1] row_mask:0xf bank_mask:0xf
    v_cndmask_b32_dpp v49, v99, v49, vcc quad_perm:[2,3,0,1] row_mask:0xf bank_mask:0xf
    v_cndmask_b32_dpp v100, v54, v100, vcc quad_perm:[2,3,0,1] row_mask:0xf bank_mask:0xf
    v_cndmask_b32_dpp v101, v55, v101, vcc quad_perm:[2,3,0,1] row_mask:0xf bank_mask:0xf
    v_cndmask_b32_dpp v104, v58, v104, vcc quad_perm:[2,3,0,1] row_mask:0xf bank_mask:0xf
    v_cndmask_b32_dpp v105, v59, v105, vcc quad_perm:[2,3,0,1] row_mask:0xf bank_mask:0xf
    v_cndmask_b32_dpp v60, v110, v60, vcc quad_perm:[2,3,0,1] row_mask:0xf bank_mask:0xf
    v_cndmask_b32_dpp v61, v111, v61, vcc quad_perm:[2,3,0,1] row_mask:0xf bank_mask:0xf
    s_mov_b64 vcc, s[12:13]
    v_cndmask_b32_dpp v52, v48, v100, vcc row_ror:12 row_mask:0xf bank_mask:0xf
    v_cndmask_b32_dpp v53, v49, v101, vcc row_ror:12 row_mask:0xf bank_mask:0xf
    v_cndmask_b32_dpp v54, v50, v102, vcc row_ror:12 row_mask:0xf bank_mask:0xf
    v_cndmask_b32_dpp v55, v51, v103, vcc row_ror:12 row_mask:0xf bank_mask:0xf
    v_cndmask_b32_dpp v108, v104, v60, vcc row_ror:12 row_mask:0xf bank_mask:0xf
    v_cndmask_b32_dpp v109, v105, v61, vcc row_ror:12 row_mask:0xf bank_mask:0xf
    v_cndmask_b32_dpp v110, v106, v62, vcc row_ror:12 row_mask:0xf bank_mask:0xf
    v_cndmask_b32_dpp v111, v107, v63, vcc row_ror:12 row_mask:0xf bank_mask:0xf
    s_not_b64 vcc, vcc
    v_cndmask_b32_dpp v48, v100, v48, vcc row_ror:4 row_mask:0xf bank_mask:0xf
    v_cndmask_b32_dpp v49, v101, v49, vcc row_ror:4 row_mask:0xf bank_mask:0xf
    v_cndmask_b32_dpp v50, v102, v50, vcc row_ror:4 row_mask:0xf bank_mask:0xf
    v_cndmask_b32_dpp v51, v103, v51, vcc row_ror:4 row_mask:0xf bank_mask:0xf
    v_cndmask_b32_dpp v104, v60, v104, vcc row_ror:4 row_mask:0xf bank_mask:0xf
    v_cndmask_b32_dpp v105, v61, v105, vcc row_ror:4 row_mask:0xf bank_mask:0xf
    v_cndmask_b32_dpp v106, v62, v106, vcc row_ror:4 row_mask:0xf bank_mask:0xf
    v_cndmask_b32_dpp v107, v63, v107, vcc row_ror:4 row_mask:0xf bank_mask:0xf
    s_mov_b64 vcc, s[14:15]
    v_cndmask_b32_dpp v56, v48, v104, vcc row_ror:8 row_mask:0xf bank_mask:0xf
    v_cndmask_b32_dpp v57, v49, v105, vcc row_ror:8 row_mask:0xf bank_mask:0xf
    v_cndmask_b32_dpp v58, v50, v106, vcc row_ror:8 row_mask:0xf bank_mask:0xf
    v_cndmask_b32_dpp v59, v51, v107, vcc row_ror:8 row_mask:0xf bank_mask:0xf
    v_cndmask_b32_dpp v60, v52, v108, vcc row_ror:8 row_mask:0xf bank_mask:0xf
    v_cndmask_b32_dpp v61, v53, v109, vcc row_ror:8 row_mask:0xf bank_mask:0xf
    v_cndmask_b32_dpp v62, v54, v110, vcc row_ror:8 row_mask:0xf bank_mask:0xf
    v_cndmask_b32_dpp v63, v55, v111, vcc row_ror:8 row_mask:0xf bank_mask:0xf
    s_not_b64 vcc, vcc
    v_cndmask_b32_dpp v48, v104, v48, vcc row_ror:8 row_mask:0xf bank_mask:0xf
    v_cndmask_b32_dpp v49, v105, v49, vcc row_ror:8 row_mask:0xf bank_mask:0xf
    v_cndmask_b32_dpp v50, v106, v50, vcc row_ror:8 row_mask:0xf bank_mask:0xf
    v_cndmask_b32_dpp v51, v107, v51, vcc row_ror:8 row_mask:0xf bank_mask:0xf
    v_cndmask_b32_dpp v52, v108, v52, vcc row_ror:8 row_mask:0xf bank_mask:0xf
    v_cndmask_b32_dpp v53, v109, v53, vcc row_ror:8 row_mask:0xf bank_mask:0xf
    v_cndmask_b32_dpp v54, v110, v54, vcc row_ror:8 row_mask:0xf bank_mask:0xf
    v_cndmask_b32_dpp v55, v111, v55, vcc row_ror:8 row_mask:0xf bank_mask:0xf
    v_mul_f32 v36, v16, v32
    v_mul_f32 v37, v17, v32
    v_fma_f32 v36, -v17, v33, v36
    v_fmac_f32 v37, v16, v33
    v_cvt_pk_bf16_f32 v64, v34, v35
    v_mul_f32 v38, v28, v32
    v_mul_f32 v39, v29, v32
    v_fma_f32 v38, -v29, v33, v38
    v_fmac_f32 v39, v28, v33
    v_cvt_pk_bf16_f32 v97, v36, v37
    v_mul_f32 v40, v30, v32
    v_mul_f32 v41, v31, v32
    v_fma_f32 v40, -v31, v33, v40
    v_fmac_f32 v41, v30, v33
    v_cvt_pk_bf16_f32 v98, v38, v39
    v_mul_f32 v42, v34, v32
    v_mul_f32 v43, v35, v32
    v_fma_f32 v42, -v35, v33, v42
    v_fmac_f32 v43, v34, v33
    v_cvt_pk_bf16_f32 v67, v40, v41
    v_mul_f32 v14, v36, v32
    v_mul_f32 v15, v37, v32
    v_fma_f32 v14, -v37, v33, v14
    v_fmac_f32 v15, v36, v33
    v_cvt_pk_bf16_f32 v100, v42, v43
    v_mul_f32 v18, v38, v32
    v_mul_f32 v19, v39, v32
    v_fma_f32 v18, -v39, v33, v18
    v_fmac_f32 v19, v38, v33
    v_cvt_pk_bf16_f32 v69, v14, v15
    v_mul_f32 v22, v40, v32
    v_mul_f32 v23, v41, v32
    v_fma_f32 v22, -v41, v33, v22
    v_fmac_f32 v23, v40, v33
    v_cvt_pk_bf16_f32 v70, v18, v19
    v_mul_f32 v16, v42, v32
    v_mul_f32 v17, v43, v32
    v_fma_f32 v16, -v43, v33, v16
    v_fmac_f32 v17, v42, v33
    v_cvt_pk_bf16_f32 v103, v22, v23
    v_mul_f32 v28, v14, v32
    v_mul_f32 v29, v15, v32
    v_fma_f32 v28, -v15, v33, v28
    v_fmac_f32 v29, v14, v33
    v_cvt_pk_bf16_f32 v104, v16, v17
    v_mul_f32 v30, v18, v32
    v_mul_f32 v31, v19, v32
    v_fma_f32 v30, -v19, v33, v30
    v_fmac_f32 v31, v18, v33
    v_cvt_pk_bf16_f32 v73, v28, v29
    v_mul_f32 v34, v22, v32
    v_mul_f32 v35, v23, v32
    v_fma_f32 v34, -v23, v33, v34
    v_fmac_f32 v35, v22, v33
    v_cvt_pk_bf16_f32 v74, v30, v31
    v_mul_f32 v36, v16, v32
    v_mul_f32 v37, v17, v32
    v_fma_f32 v36, -v17, v33, v36
    v_fmac_f32 v37, v16, v33
    v_cvt_pk_bf16_f32 v107, v34, v35
    v_mul_f32 v38, v28, v32
    v_mul_f32 v39, v29, v32
    v_fma_f32 v38, -v29, v33, v38
    v_fmac_f32 v39, v28, v33
    v_cvt_pk_bf16_f32 v76, v36, v37
    v_mul_f32 v40, v30, v32
    v_mul_f32 v41, v31, v32
    v_fma_f32 v40, -v31, v33, v40
    v_fmac_f32 v41, v30, v33
    v_cvt_pk_bf16_f32 v109, v38, v39
    v_mul_f32 v42, v34, v32
    v_mul_f32 v43, v35, v32
    v_fma_f32 v42, -v35, v33, v42
    v_fmac_f32 v43, v34, v33
    v_cvt_pk_bf16_f32 v110, v40, v41
    v_mul_f32 v14, v26, v20
    v_mul_f32 v15, v27, v20
    v_fma_f32 v14, v27, v21, v14
    v_fma_f32 v15, -v26, v21, v15
    v_cvt_pk_bf16_f32 v79, v42, v43
    s_nop 0
    s_mov_b64 vcc, s[8:9]
    v_cndmask_b32_dpp v65, v64, v97, vcc quad_perm:[1,0,3,2] row_mask:0xf bank_mask:0xf
    v_cndmask_b32_dpp v99, v98, v67, vcc quad_perm:[1,0,3,2] row_mask:0xf bank_mask:0xf
    v_cndmask_b32_dpp v101, v100, v69, vcc quad_perm:[1,0,3,2] row_mask:0xf bank_mask:0xf
    v_cndmask_b32_dpp v71, v70, v103, vcc quad_perm:[1,0,3,2] row_mask:0xf bank_mask:0xf
    v_cndmask_b32_dpp v105, v104, v73, vcc quad_perm:[1,0,3,2] row_mask:0xf bank_mask:0xf
    v_cndmask_b32_dpp v75, v74, v107, vcc quad_perm:[1,0,3,2] row_mask:0xf bank_mask:0xf
    v_cndmask_b32_dpp v77, v76, v109, vcc quad_perm:[1,0,3,2] row_mask:0xf bank_mask:0xf
    v_cndmask_b32_dpp v111, v110, v79, vcc quad_perm:[1,0,3,2] row_mask:0xf bank_mask:0xf
    s_not_b64 vcc, vcc
    v_cndmask_b32_dpp v64, v97, v64, vcc quad_perm:[1,0,3,2] row_mask:0xf bank_mask:0xf
    v_cndmask_b32_dpp v98, v67, v98, vcc quad_perm:[1,0,3,2] row_mask:0xf bank_mask:0xf
    v_cndmask_b32_dpp v100, v69, v100, vcc quad_perm:[1,0,3,2] row_mask:0xf bank_mask:0xf
    v_cndmask_b32_dpp v70, v103, v70, vcc quad_perm:[1,0,3,2] row_mask:0xf bank_mask:0xf
    v_cndmask_b32_dpp v104, v73, v104, vcc quad_perm:[1,0,3,2] row_mask:0xf bank_mask:0xf
    v_cndmask_b32_dpp v74, v107, v74, vcc quad_perm:[1,0,3,2] row_mask:0xf bank_mask:0xf
    v_cndmask_b32_dpp v76, v109, v76, vcc quad_perm:[1,0,3,2] row_mask:0xf bank_mask:0xf
    v_cndmask_b32_dpp v110, v79, v110, vcc quad_perm:[1,0,3,2] row_mask:0xf bank_mask:0xf
    s_mov_b64 vcc, s[10:11]
    v_cndmask_b32_dpp v66, v64, v98, vcc quad_perm:[2,3,0,1] row_mask:0xf bank_mask:0xf
    v_cndmask_b32_dpp v67, v65, v99, vcc quad_perm:[2,3,0,1] row_mask:0xf bank_mask:0xf
    v_cndmask_b32_dpp v102, v100, v70, vcc quad_perm:[2,3,0,1] row_mask:0xf bank_mask:0xf
    v_cndmask_b32_dpp v103, v101, v71, vcc quad_perm:[2,3,0,1] row_mask:0xf bank_mask:0xf
    v_cndmask_b32_dpp v106, v104, v74, vcc quad_perm:[2,3,0,1] row_mask:0xf bank_mask:0xf
    v_cndmask_b32_dpp v107, v105, v75, vcc quad_perm:[2,3,0,1] row_mask:0xf bank_mask:0xf
    v_cndmask_b32_dpp v78, v76, v110, vcc quad_perm:[2,3,0,1] row_mask:0xf bank_mask:0xf
    v_cndmask_b32_dpp v79, v77, v111, vcc quad_perm:[2,3,0,1] row_mask:0xf bank_mask:0xf
    s_not_b64 vcc, vcc
    v_cndmask_b32_dpp v64, v98, v64, vcc quad_perm:[2,3,0,1] row_mask:0xf bank_mask:0xf
    v_cndmask_b32_dpp v65, v99, v65, vcc quad_perm:[2,3,0,1] row_mask:0xf bank_mask:0xf
    v_cndmask_b32_dpp v100, v70, v100, vcc quad_perm:[2,3,0,1] row_mask:0xf bank_mask:0xf
    v_cndmask_b32_dpp v101, v71, v101, vcc quad_perm:[2,3,0,1] row_mask:0xf bank_mask:0xf
    v_cndmask_b32_dpp v104, v74, v104, vcc quad_perm:[2,3,0,1] row_mask:0xf bank_mask:0xf
    v_cndmask_b32_dpp v105, v75, v105, vcc quad_perm:[2,3,0,1] row_mask:0xf bank_mask:0xf
    v_cndmask_b32_dpp v76, v110, v76, vcc quad_perm:[2,3,0,1] row_mask:0xf bank_mask:0xf
    v_cndmask_b32_dpp v77, v111, v77, vcc quad_perm:[2,3,0,1] row_mask:0xf bank_mask:0xf
    s_mov_b64 vcc, s[12:13]
    v_cndmask_b32_dpp v68, v64, v100, vcc row_ror:12 row_mask:0xf bank_mask:0xf
    v_cndmask_b32_dpp v69, v65, v101, vcc row_ror:12 row_mask:0xf bank_mask:0xf
    v_cndmask_b32_dpp v70, v66, v102, vcc row_ror:12 row_mask:0xf bank_mask:0xf
    v_cndmask_b32_dpp v71, v67, v103, vcc row_ror:12 row_mask:0xf bank_mask:0xf
    v_cndmask_b32_dpp v108, v104, v76, vcc row_ror:12 row_mask:0xf bank_mask:0xf
    v_cndmask_b32_dpp v109, v105, v77, vcc row_ror:12 row_mask:0xf bank_mask:0xf
    v_cndmask_b32_dpp v110, v106, v78, vcc row_ror:12 row_mask:0xf bank_mask:0xf
    v_cndmask_b32_dpp v111, v107, v79, vcc row_ror:12 row_mask:0xf bank_mask:0xf
    s_not_b64 vcc, vcc
    v_cndmask_b32_dpp v64, v100, v64, vcc row_ror:4 row_mask:0xf bank_mask:0xf
    v_cndmask_b32_dpp v65, v101, v65, vcc row_ror:4 row_mask:0xf bank_mask:0xf
    v_cndmask_b32_dpp v66, v102, v66, vcc row_ror:4 row_mask:0xf bank_mask:0xf
    v_cndmask_b32_dpp v67, v103, v67, vcc row_ror:4 row_mask:0xf bank_mask:0xf
    v_cndmask_b32_dpp v104, v76, v104, vcc row_ror:4 row_mask:0xf bank_mask:0xf
    v_cndmask_b32_dpp v105, v77, v105, vcc row_ror:4 row_mask:0xf bank_mask:0xf
    v_cndmask_b32_dpp v106, v78, v106, vcc row_ror:4 row_mask:0xf bank_mask:0xf
    v_cndmask_b32_dpp v107, v79, v107, vcc row_ror:4 row_mask:0xf bank_mask:0xf
    s_mov_b64 vcc, s[14:15]
    v_cndmask_b32_dpp v72, v64, v104, vcc row_ror:8 row_mask:0xf bank_mask:0xf
    v_cndmask_b32_dpp v73, v65, v105, vcc row_ror:8 row_mask:0xf bank_mask:0xf
    v_cndmask_b32_dpp v74, v66, v106, vcc row_ror:8 row_mask:0xf bank_mask:0xf
    v_cndmask_b32_dpp v75, v67, v107, vcc row_ror:8 row_mask:0xf bank_mask:0xf
    v_cndmask_b32_dpp v76, v68, v108, vcc row_ror:8 row_mask:0xf bank_mask:0xf
    v_cndmask_b32_dpp v77, v69, v109, vcc row_ror:8 row_mask:0xf bank_mask:0xf
    v_cndmask_b32_dpp v78, v70, v110, vcc row_ror:8 row_mask:0xf bank_mask:0xf
    v_cndmask_b32_dpp v79, v71, v111, vcc row_ror:8 row_mask:0xf bank_mask:0xf
    s_not_b64 vcc, vcc
    v_cndmask_b32_dpp v64, v104, v64, vcc row_ror:8 row_mask:0xf bank_mask:0xf
    v_cndmask_b32_dpp v65, v105, v65, vcc row_ror:8 row_mask:0xf bank_mask:0xf
    v_cndmask_b32_dpp v66, v106, v66, vcc row_ror:8 row_mask:0xf bank_mask:0xf
    v_cndmask_b32_dpp v67, v107, v67, vcc row_ror:8 row_mask:0xf bank_mask:0xf
    v_cndmask_b32_dpp v68, v108, v68, vcc row_ror:8 row_mask:0xf bank_mask:0xf
    v_cndmask_b32_dpp v69, v109, v69, vcc row_ror:8 row_mask:0xf bank_mask:0xf
    v_cndmask_b32_dpp v70, v110, v70, vcc row_ror:8 row_mask:0xf bank_mask:0xf
    v_cndmask_b32_dpp v71, v111, v71, vcc row_ror:8 row_mask:0xf bank_mask:0xf
    v_mul_f32 v18, v26, v24
    v_mul_f32 v19, v27, v24
    v_fma_f32 v18, v27, v25, v18
    v_fma_f32 v19, -v26, v25, v19
    v_cvt_pk_bf16_f32 v100, v26, v27
    v_cvt_pk_bf16_f32 v85, v14, v15
    v_mul_f32 v22, v14, v20
    v_mul_f32 v23, v15, v20
    v_fma_f32 v22, v15, v21, v22
    v_fma_f32 v23, -v14, v21, v23
    v_cvt_pk_bf16_f32 v80, v18, v19
    v_mul_f32 v16, v18, v24
    v_mul_f32 v17, v19, v24
    v_fma_f32 v16, v19, v25, v16
    v_fma_f32 v17, -v18, v25, v17
    v_cvt_pk_bf16_f32 v86, v22, v23
    v_mul_f32 v28, v22, v20
    v_mul_f32 v29, v23, v20
    v_fma_f32 v28, v23, v21, v28
    v_fma_f32 v29, -v22, v21, v29
    v_cvt_pk_bf16_f32 v97, v16, v17
    v_mul_f32 v30, v16, v24
    v_mul_f32 v31, v17, v24
    v_fma_f32 v30, v17, v25, v30
    v_fma_f32 v31, -v16, v25, v31
    v_cvt_pk_bf16_f32 v103, v28, v29
    v_mul_f32 v34, v28, v20
    v_mul_f32 v35, v29, v20
    v_fma_f32 v34, v29, v21, v34
    v_fma_f32 v35, -v28, v21, v35
    v_cvt_pk_bf16_f32 v98, v30, v31
    v_mul_f32 v36, v30, v24
    v_mul_f32 v37, v31, v24
    v_fma_f32 v36, v31, v25, v36
    v_fma_f32 v37, -v30, v25, v37
    v_cvt_pk_bf16_f32 v104, v34, v35
    v_mul_f32 v38, v34, v20
    v_mul_f32 v39, v35, v20
    v_fma_f32 v38, v35, v21, v38
    v_fma_f32 v39, -v34, v21, v39
    v_cvt_pk_bf16_f32 v83, v36, v37
    v_mul_f32 v40, v22, v24
    v_mul_f32 v41, v23, v24
    v_fma_f32 v40, v23, v25, v40
    v_fma_f32 v41, -v22, v25, v41
    v_cvt_pk_bf16_f32 v89, v38, v39
    v_mul_f32 v42, v38, v20
    v_mul_f32 v43, v39, v20
    v_fma_f32 v42, v39, v21, v42
    v_fma_f32 v43, -v38, v21, v43
    v_cvt_pk_bf16_f32 v92, v40, v41
    v_mul_f32 v32, v34, v24
    v_mul_f32 v33, v35, v24
    v_fma_f32 v32, v35, v25, v32
    v_fma_f32 v33, -v34, v25, v33
    v_cvt_pk_bf16_f32 v90, v42, v43
    v_mul_f32 v18, v42, v20
    v_mul_f32 v19, v43, v20
    v_fma_f32 v18, v43, v21, v18
    v_fma_f32 v19, -v42, v21, v19
    v_cvt_pk_bf16_f32 v109, v32, v33
    v_mul_f32 v14, v42, v24
    v_mul_f32 v15, v43, v24
    v_fma_f32 v14, v43, v25, v14
    v_fma_f32 v15, -v42, v25, v15
    v_cvt_pk_bf16_f32 v107, v18, v19
    v_mul_f32 v16, v32, v24
    v_mul_f32 v17, v33, v24
    v_fma_f32 v16, v33, v25, v16
    v_fma_f32 v17, -v32, v25, v17
    v_cvt_pk_bf16_f32 v110, v14, v15
    v_mul_f32 v30, v36, v24
    v_mul_f32 v31, v37, v24
    v_fma_f32 v30, v37, v25, v30
    v_fma_f32 v31, -v36, v25, v31
    v_cvt_pk_bf16_f32 v95, v16, v17
    s_nop 0
    s_mov_b64 vcc, s[8:9]
    v_cndmask_b32_dpp v81, v80, v97, vcc quad_perm:[1,0,3,2] row_mask:0xf bank_mask:0xf
    v_cndmask_b32_dpp v99, v98, v83, vcc quad_perm:[1,0,3,2] row_mask:0xf bank_mask:0xf
    v_cndmask_b32_dpp v101, v100, v85, vcc quad_perm:[1,0,3,2] row_mask:0xf bank_mask:0xf
    v_cndmask_b32_dpp v87, v86, v103, vcc quad_perm:[1,0,3,2] row_mask:0xf bank_mask:0xf
    v_cndmask_b32_dpp v105, v104, v89, vcc quad_perm:[1,0,3,2] row_mask:0xf bank_mask:0xf
    v_cndmask_b32_dpp v91, v90, v107, vcc quad_perm:[1,0,3,2] row_mask:0xf bank_mask:0xf
    v_cndmask_b32_dpp v93, v92, v109, vcc quad_perm:[1,0,3,2] row_mask:0xf bank_mask:0xf
    v_cndmask_b32_dpp v111, v110, v95, vcc quad_perm:[1,0,3,2] row_mask:0xf bank_mask:0xf
    s_not_b64 vcc, vcc
    v_cndmask_b32_dpp v80, v97, v80, vcc quad_perm:[1,0,3,2] row_mask:0xf bank_mask:0xf
    v_cndmask_b32_dpp v98, v83, v98, vcc quad_perm:[1,0,3,2] row_mask:0xf bank_mask:0xf
    v_cndmask_b32_dpp v100, v85, v100, vcc quad_perm:[1,0,3,2] row_mask:0xf bank_mask:0xf
    v_cndmask_b32_dpp v86, v103, v86, vcc quad_perm:[1,0,3,2] row_mask:0xf bank_mask:0xf
    v_cndmask_b32_dpp v104, v89, v104, vcc quad_perm:[1,0,3,2] row_mask:0xf bank_mask:0xf
    v_cndmask_b32_dpp v90, v107, v90, vcc quad_perm:[1,0,3,2] row_mask:0xf bank_mask:0xf
    v_cndmask_b32_dpp v92, v109, v92, vcc quad_perm:[1,0,3,2] row_mask:0xf bank_mask:0xf
    v_cndmask_b32_dpp v110, v95, v110, vcc quad_perm:[1,0,3,2] row_mask:0xf bank_mask:0xf
    s_mov_b64 vcc, s[10:11]
    v_cndmask_b32_dpp v82, v80, v98, vcc quad_perm:[2,3,0,1] row_mask:0xf bank_mask:0xf
    v_cndmask_b32_dpp v83, v81, v99, vcc quad_perm:[2,3,0,1] row_mask:0xf bank_mask:0xf
    v_cndmask_b32_dpp v102, v100, v86, vcc quad_perm:[2,3,0,1] row_mask:0xf bank_mask:0xf
    v_cndmask_b32_dpp v103, v101, v87, vcc quad_perm:[2,3,0,1] row_mask:0xf bank_mask:0xf
    v_cndmask_b32_dpp v106, v104, v90, vcc quad_perm:[2,3,0,1] row_mask:0xf bank_mask:0xf
    v_cndmask_b32_dpp v107, v105, v91, vcc quad_perm:[2,3,0,1] row_mask:0xf bank_mask:0xf
    v_cndmask_b32_dpp v94, v92, v110, vcc quad_perm:[2,3,0,1] row_mask:0xf bank_mask:0xf
    v_cndmask_b32_dpp v95, v93, v111, vcc quad_perm:[2,3,0,1] row_mask:0xf bank_mask:0xf
    s_not_b64 vcc, vcc
    v_cndmask_b32_dpp v80, v98, v80, vcc quad_perm:[2,3,0,1] row_mask:0xf bank_mask:0xf
    v_cndmask_b32_dpp v81, v99, v81, vcc quad_perm:[2,3,0,1] row_mask:0xf bank_mask:0xf
    v_cndmask_b32_dpp v100, v86, v100, vcc quad_perm:[2,3,0,1] row_mask:0xf bank_mask:0xf
    v_cndmask_b32_dpp v101, v87, v101, vcc quad_perm:[2,3,0,1] row_mask:0xf bank_mask:0xf
    v_cndmask_b32_dpp v104, v90, v104, vcc quad_perm:[2,3,0,1] row_mask:0xf bank_mask:0xf
    v_cndmask_b32_dpp v105, v91, v105, vcc quad_perm:[2,3,0,1] row_mask:0xf bank_mask:0xf
    v_cndmask_b32_dpp v92, v110, v92, vcc quad_perm:[2,3,0,1] row_mask:0xf bank_mask:0xf
    v_cndmask_b32_dpp v93, v111, v93, vcc quad_perm:[2,3,0,1] row_mask:0xf bank_mask:0xf
    s_mov_b64 vcc, s[12:13]
    v_cndmask_b32_dpp v84, v80, v100, vcc row_ror:12 row_mask:0xf bank_mask:0xf
    v_cndmask_b32_dpp v85, v81, v101, vcc row_ror:12 row_mask:0xf bank_mask:0xf
    v_cndmask_b32_dpp v86, v82, v102, vcc row_ror:12 row_mask:0xf bank_mask:0xf
    v_cndmask_b32_dpp v87, v83, v103, vcc row_ror:12 row_mask:0xf bank_mask:0xf
    v_cndmask_b32_dpp v108, v104, v92, vcc row_ror:12 row_mask:0xf bank_mask:0xf
    v_cndmask_b32_dpp v109, v105, v93, vcc row_ror:12 row_mask:0xf bank_mask:0xf
    v_cndmask_b32_dpp v110, v106, v94, vcc row_ror:12 row_mask:0xf bank_mask:0xf
    v_cndmask_b32_dpp v111, v107, v95, vcc row_ror:12 row_mask:0xf bank_mask:0xf
    s_not_b64 vcc, vcc
    v_cndmask_b32_dpp v80, v100, v80, vcc row_ror:4 row_mask:0xf bank_mask:0xf
    v_cndmask_b32_dpp v81, v101, v81, vcc row_ror:4 row_mask:0xf bank_mask:0xf
    v_cndmask_b32_dpp v82, v102, v82, vcc row_ror:4 row_mask:0xf bank_mask:0xf
    v_cndmask_b32_dpp v83, v103, v83, vcc row_ror:4 row_mask:0xf bank_mask:0xf
    v_cndmask_b32_dpp v104, v92, v104, vcc row_ror:4 row_mask:0xf bank_mask:0xf
    v_cndmask_b32_dpp v105, v93, v105, vcc row_ror:4 row_mask:0xf bank_mask:0xf
    v_cndmask_b32_dpp v106, v94, v106, vcc row_ror:4 row_mask:0xf bank_mask:0xf
    v_cndmask_b32_dpp v107, v95, v107, vcc row_ror:4 row_mask:0xf bank_mask:0xf
    s_mov_b64 vcc, s[14:15]
    v_cndmask_b32_dpp v88, v80, v104, vcc row_ror:8 row_mask:0xf bank_mask:0xf
    v_cndmask_b32_dpp v89, v81, v105, vcc row_ror:8 row_mask:0xf bank_mask:0xf
    v_cndmask_b32_dpp v90, v82, v106, vcc row_ror:8 row_mask:0xf bank_mask:0xf
    v_cndmask_b32_dpp v91, v83, v107, vcc row_ror:8 row_mask:0xf bank_mask:0xf
    v_cndmask_b32_dpp v92, v84, v108, vcc row_ror:8 row_mask:0xf bank_mask:0xf
    v_cndmask_b32_dpp v93, v85, v109, vcc row_ror:8 row_mask:0xf bank_mask:0xf
    v_cndmask_b32_dpp v94, v86, v110, vcc row_ror:8 row_mask:0xf bank_mask:0xf
    v_cndmask_b32_dpp v95, v87, v111, vcc row_ror:8 row_mask:0xf bank_mask:0xf
    s_not_b64 vcc, vcc
    v_cndmask_b32_dpp v80, v104, v80, vcc row_ror:8 row_mask:0xf bank_mask:0xf
    v_cndmask_b32_dpp v81, v105, v81, vcc row_ror:8 row_mask:0xf bank_mask:0xf
    v_cndmask_b32_dpp v82, v106, v82, vcc row_ror:8 row_mask:0xf bank_mask:0xf
    v_cndmask_b32_dpp v83, v107, v83, vcc row_ror:8 row_mask:0xf bank_mask:0xf
    v_cndmask_b32_dpp v84, v108, v84, vcc row_ror:8 row_mask:0xf bank_mask:0xf
    v_cndmask_b32_dpp v85, v109, v85, vcc row_ror:8 row_mask:0xf bank_mask:0xf
    v_cndmask_b32_dpp v86, v110, v86, vcc row_ror:8 row_mask:0xf bank_mask:0xf
    v_cndmask_b32_dpp v87, v111, v87, vcc row_ror:8 row_mask:0xf bank_mask:0xf
    s_nop 1
    v_mfma_f32_16x16x32_bf16 v[112:115], v[80:83], v[48:51], v[112:115]
    v_mfma_f32_16x16x32_bf16 v[116:119], v[80:83], v[64:67], v[116:119]
    v_mfma_f32_16x16x32_bf16 v[112:115], v[84:87], v[52:55], v[112:115]
    v_mfma_f32_16x16x32_bf16 v[116:119], v[84:87], v[68:71], v[116:119]
    v_mfma_f32_16x16x32_bf16 v[112:115], v[88:91], v[56:59], v[112:115]
    v_mfma_f32_16x16x32_bf16 v[116:119], v[88:91], v[72:75], v[116:119]
    v_mfma_f32_16x16x32_bf16 v[112:115], v[92:95], v[60:63], v[112:115]
    v_mfma_f32_16x16x32_bf16 v[116:119], v[92:95], v[76:79], v[116:119]
    v_mul_f32 v28, v30, v24
    v_mul_f32 v29, v31, v24
    v_fma_f32 v28, v31, v25, v28
    v_fma_f32 v29, -v30, v25, v29
    v_mul_f32 v22, v16, v24
    v_mul_f32 v23, v17, v24
    v_fma_f32 v22, v17, v25, v22
    v_fma_f32 v23, -v16, v25, v23
    v_mul_f32 v34, v28, v24
    v_mul_f32 v35, v29, v24
    v_fma_f32 v34, v29, v25, v34
    v_fma_f32 v35, -v28, v25, v35
    v_mul_f32 v38, v34, v24
    v_mul_f32 v39, v35, v24
    v_fma_f32 v38, v35, v25, v38
    v_fma_f32 v39, -v34, v25, v39
    v_cvt_pk_bf16_f32 v80, v30, v31
    v_cvt_pk_bf16_f32 v97, v28, v29
    v_cvt_pk_bf16_f32 v108, v22, v23
    v_cvt_pk_bf16_f32 v98, v34, v35
    v_cvt_pk_bf16_f32 v83, v38, v39
    s_nop 0
    s_mov_b64 vcc, s[8:9]
    v_cndmask_b32_dpp v81, v80, v97, vcc quad_perm:[1,0,3,2] row_mask:0xf bank_mask:0xf
    v_cndmask_b32_dpp v99, v98, v83, vcc quad_perm:[1,0,3,2] row_mask:0xf bank_mask:0xf
    v_mov_b32_dpp v109, v108 quad_perm:[1,0,3,2] row_mask:0xf bank_mask:0xf
    s_not_b64 vcc, vcc
    v_cndmask_b32_dpp v80, v97, v80, vcc quad_perm:[1,0,3,2] row_mask:0xf bank_mask:0xf
    v_cndmask_b32_dpp v98, v83, v98, vcc quad_perm:[1,0,3,2] row_mask:0xf bank_mask:0xf
    s_mov_b64 vcc, s[10:11]
    v_cndmask_b32_dpp v82, v80, v98, vcc quad_perm:[2,3,0,1] row_mask:0xf bank_mask:0xf
    v_cndmask_b32_dpp v83, v81, v99, vcc quad_perm:[2,3,0,1] row_mask:0xf bank_mask:0xf
    v_mov_b32_dpp v110, v108 quad_perm:[2,3,0,1] row_mask:0xf bank_mask:0xf
    v_mov_b32_dpp v111, v109 quad_perm:[2,3,0,1] row_mask:0xf bank_mask:0xf
    s_not_b64 vcc, vcc
    v_cndmask_b32_dpp v80, v98, v80, vcc quad_perm:[2,3,0,1] row_mask:0xf bank_mask:0xf
    v_cndmask_b32_dpp v81, v99, v81, vcc quad_perm:[2,3,0,1] row_mask:0xf bank_mask:0xf
    s_nop 0
    v_mov_b32_dpp v84, v80 row_ror:12 row_mask:0xf bank_mask:0xf
    v_mov_b32_dpp v85, v81 row_ror:12 row_mask:0xf bank_mask:0xf
    v_mov_b32_dpp v86, v82 row_ror:12 row_mask:0xf bank_mask:0xf
    v_mov_b32_dpp v87, v83 row_ror:12 row_mask:0xf bank_mask:0xf
    v_mov_b32_dpp v104, v108 row_ror:4 row_mask:0xf bank_mask:0xf
    v_mov_b32_dpp v105, v109 row_ror:4 row_mask:0xf bank_mask:0xf
    v_mov_b32_dpp v106, v110 row_ror:4 row_mask:0xf bank_mask:0xf
    v_mov_b32_dpp v107, v111 row_ror:4 row_mask:0xf bank_mask:0xf
    s_mov_b64 vcc, s[14:15]
    v_cndmask_b32_dpp v88, v80, v104, vcc row_ror:8 row_mask:0xf bank_mask:0xf
    v_cndmask_b32_dpp v89, v81, v105, vcc row_ror:8 row_mask:0xf bank_mask:0xf
    v_cndmask_b32_dpp v90, v82, v106, vcc row_ror:8 row_mask:0xf bank_mask:0xf
    v_cndmask_b32_dpp v91, v83, v107, vcc row_ror:8 row_mask:0xf bank_mask:0xf
    v_cndmask_b32_dpp v92, v84, v108, vcc row_ror:8 row_mask:0xf bank_mask:0xf
    v_cndmask_b32_dpp v93, v85, v109, vcc row_ror:8 row_mask:0xf bank_mask:0xf
    v_cndmask_b32_dpp v94, v86, v110, vcc row_ror:8 row_mask:0xf bank_mask:0xf
    v_cndmask_b32_dpp v95, v87, v111, vcc row_ror:8 row_mask:0xf bank_mask:0xf
    s_not_b64 vcc, vcc
    v_cndmask_b32_dpp v80, v104, v80, vcc row_ror:8 row_mask:0xf bank_mask:0xf
    v_cndmask_b32_dpp v81, v105, v81, vcc row_ror:8 row_mask:0xf bank_mask:0xf
    v_cndmask_b32_dpp v82, v106, v82, vcc row_ror:8 row_mask:0xf bank_mask:0xf
    v_cndmask_b32_dpp v83, v107, v83, vcc row_ror:8 row_mask:0xf bank_mask:0xf
    v_cndmask_b32_dpp v84, v108, v84, vcc row_ror:8 row_mask:0xf bank_mask:0xf
    v_cndmask_b32_dpp v85, v109, v85, vcc row_ror:8 row_mask:0xf bank_mask:0xf
    v_cndmask_b32_dpp v86, v110, v86, vcc row_ror:8 row_mask:0xf bank_mask:0xf
    v_cndmask_b32_dpp v87, v111, v87, vcc row_ror:8 row_mask:0xf bank_mask:0xf
    s_nop 1
    v_mfma_f32_16x16x32_bf16 v[120:123], v[80:83], v[48:51], v[120:123]
    v_mfma_f32_16x16x32_bf16 v[124:127], v[80:83], v[64:67], v[124:127]
    v_mfma_f32_16x16x32_bf16 v[120:123], v[84:87], v[52:55], v[120:123]
    v_mfma_f32_16x16x32_bf16 v[124:127], v[84:87], v[68:71], v[124:127]
    v_mfma_f32_16x16x32_bf16 v[120:123], v[88:91], v[56:59], v[120:123]
    v_mfma_f32_16x16x32_bf16 v[124:127], v[88:91], v[72:75], v[124:127]
    v_mfma_f32_16x16x32_bf16 v[120:123], v[92:95], v[60:63], v[120:123]
    v_mfma_f32_16x16x32_bf16 v[124:127], v[92:95], v[76:79], v[124:127]
    global_load_dword v8, v3, s[40:41] sc1
    s_lshr_b32 s65, s2, 3
    s_mul_i32 s65, s65, 12544
    s_lshl_b32 s68, s3, 12
    s_add_u32 s65, s65, s68
    v_lshlrev_b32 v9, 6, v1
    buffer_load_dword v7, v9, s[48:51], s65 offen
    ds_write_b32 v12, v112 offset:0
    ds_write_b32 v12, v113 offset:128
    ds_write_b32 v12, v114 offset:256
    ds_write_b32 v12, v115 offset:384
    ds_write_b32 v12, v116 offset:64
    ds_write_b32 v12, v117 offset:192
    ds_write_b32 v12, v118 offset:320
    ds_write_b32 v12, v119 offset:448
    ds_write_b32 v12, v120 offset:512
    ds_write_b32 v12, v121 offset:640
    ds_write_b32 v12, v122 offset:768
    ds_write_b32 v12, v123 offset:896
    ds_write_b32 v12, v124 offset:576
    ds_write_b32 v12, v125 offset:704
    ds_write_b32 v12, v126 offset:832
    ds_write_b32 v12, v127 offset:960
    s_mov_b64 exec, 1
    ds_add_u32 v6, v4 offset:18456
    s_mov_b64 exec, -1
    s_setprio 2
    s_mul_i32 s80, s76, 1171
    s_lshr_b32 s80, s80, 16
    s_mul_i32 s65, s80, 56
    s_sub_u32 s65, s76, s65
    s_lshr_b32 s66, s65, 4
    s_lshr_b32 s65, s65, 5
    s_lshl_b32 s81, s80, 2
    s_add_u32 s66, s66, s81
    s_lshl_b32 s66, s66, 12
    s_add_u32 s84, s66, 393216
    s_lshl_b32 s66, s80, 1
    s_add_u32 s65, s65, s66
    s_lshl_b32 s65, s65, 12
    s_add_u32 s81, s65, 294912
    v_lshlrev_b32 v9, 6, v1
    s_mul_i32 s77, s6, 9216
    s_waitcnt vmcnt(0)
N31:
    v_readfirstlane_b32 s60, v8
    s_cmp_lg_u32 s60, 0
    s_cbranch_scc1 D32
    s_sub_u32 s61, s61, 1
    s_cbranch_scc1 BAIL
    global_load_dword v8, v3, s[40:41] sc1
    s_waitcnt vmcnt(0)
    s_branch N31
D32:
    buffer_load_dword v10, v9, s[44:47], s81 offen sc1
W33:
    ds_read_b32 v5, v6 offset:18456
    s_waitcnt lgkmcnt(0)
    v_readfirstlane_b32 s64, v5
    s_cmp_ge_u32 s64, 2
    s_cbranch_scc1 D34
    s_sub_u32 s61, s61, 1
    s_cbranch_scc1 BAIL
    s_sleep 1
    s_branch W33
D34:
    v_accvgpr_read_b32 v15, a15
    v_accvgpr_read_b32 v18, a19
    v_accvgpr_read_b32 v14, a16
    ds_read_b32 v16, v15 offset:384
    ds_read_b32 v17, v15 offset:4992
    ds_read_b32 v20, v15 offset:388
    ds_read_b32 v21, v15 offset:4996
    s_cmp_eq_u32 s7, 0
    s_cbranch_scc1 H_T0
    ds_read_b32 v24, v18 offset:0
    ds_read_b32 v25, v18 offset:4608
    ds_read_b32 v26, v18 offset:4
    ds_read_b32 v27, v18 offset:4612
    ds_read_b32 v28, v15 offset:3392
    ds_read_b32 v29, v15 offset:8000
    s_waitcnt lgkmcnt(0)
    v_add_f32 v24, v24, v25
    v_add_f32 v26, v26, v27
    v_add_f32 v28, v28, v29
    v_cvt_pk_bf16_f32 v48, v26, v26
    v_cvt_pk_bf16_f32 v49, v28, v28
    v_cvt_pk_bf16_f32 v50, v28, v24
    v_cvt_pk_bf16_f32 v51, v24, v24
    v_mov_b32 v30, v51
    s_branch H_T2
H_T0:
    s_mov_b32 exec_hi, 0
    ds_read_b32 v32, v18 offset:1088
    ds_read_b32 v33, v18 offset:5696
    ds_read_b32 v34, v18 offset:1216
    ds_read_b32 v35, v18 offset:5824
    ds_read_b32 v36, v18 offset:1344
    ds_read_b32 v37, v18 offset:5952
    ds_read_b32 v38, v18 offset:1472
    ds_read_b32 v39, v18 offset:6080
    ds_read_b32 v40, v18 offset:2176
    ds_read_b32 v41, v18 offset:6784
    ds_read_b32 v42, v18 offset:2304
    ds_read_b32 v43, v18 offset:6912
    ds_read_b32 v44, v18 offset:2432
    ds_read_b32 v45, v18 offset:7040
    ds_read_b32 v46, v18 offset:2560
    ds_read_b32 v47, v18 offset:7168
    s_not_b64 exec, exec
    ds_read_b32 v32, v18 offset:0
    ds_read_b32 v33, v18 offset:4608
    ds_read_b32 v34, v18 offset:0
    ds_read_b32 v35, v18 offset:4608
    ds_read_b32 v36, v18 offset:3264
    ds_read_b32 v37, v18 offset:7872
    ds_read_b32 v38, v18 offset:3392
    ds_read_b32 v39, v18 offset:8000
    ds_read_b32 v40, v18 offset:3392
    ds_read_b32 v41, v18 offset:8000
    ds_read_b32 v42, v18 offset:3392
    ds_read_b32 v43, v18 offset:8000
    ds_read_b32 v44, v18 offset:3520
    ds_read_b32 v45, v18 offset:8128
    ds_read_b32 v46, v18 offset:4
    ds_read_b32 v47, v18 offset:4612
    s_mov_b64 exec, -1
    s_waitcnt lgkmcnt(0)
    v_add_f32 v32, v32, v33
    v_add_f32 v34, v34, v35
    v_add_f32 v36, v36, v37
    v_add_f32 v38, v38, v39
    v_add_f32 v40, v40, v41
    v_add_f32 v42, v42, v43
    v_add_f32 v44, v44, v45
    v_add_f32 v46, v46, v47
    s_mov_b64 exec, 1
    v_add_f32 v32, s67, v32
    s_mov_b64 exec, -1
    v_mov_b32 v30, 0
    v_cvt_pk_bf16_f32 v48, v46, v44
    v_cvt_pk_bf16_f32 v49, v42, v40
    v_cvt_pk_bf16_f32 v50, v38, v36
    v_cvt_pk_bf16_f32 v51, v34, v32
    s_nop 1
    v_mov_b32_dpp v30, v48 wave_shr:1 row_mask:0xf bank_mask:0xf
H_T2:
    v_add_f32 v16, v16, v17
    v_add_f32 v20, v20, v21
    v_cndmask_b32 v24, v16, v20, s[8:9]
    v_cvt_pk_bf16_f32 v56, v20, v20
    v_cvt_pk_bf16_f32 v57, v20, v24
    v_cvt_pk_bf16_f32 v58, v16, v16
    v_cvt_pk_bf16_f32 v59, v16, v16
    v_alignbit_b32 v52, v49, v48, 16
    v_alignbit_b32 v53, v50, v49, 16
    v_alignbit_b32 v54, v51, v50, 16
    v_alignbit_b32 v55, v30, v51, 16
    v_alignbit_b32 v60, v57, v56, 16
    v_alignbit_b32 v61, v58, v57, 16
    v_mov_b32 v62, v58
    v_mov_b32 v63, v58
    s_mul_i32 s77, s6, 8384
    s_add_u32 s77, s77, 18944
    v_accvgpr_read_b32 v18, a17
    v_accvgpr_read_b32 v19, a18
H_XPOLL:
    s_waitcnt vmcnt(0)
    v_cmp_ne_u32 vcc, s60, v10
    s_cbranch_vccz H_XOK
    s_sub_u32 s61, s61, 1
    s_cbranch_scc1 BAIL
    s_sleep 2
    buffer_load_dword v10, v9, s[44:47], s81 offen sc1
    s_branch H_XPOLL
H_XOK:
    s_lshl_b32 s65, s76, 13
    s_lshl_b32 s66, s7, 12
    s_add_u32 s65, s65, s66
    s_lshl_b32 s66, s6, 6
    s_add_u32 s65, s65, s66
    s_add_u32 s83, s65, 524288
    buffer_load_dwordx4 v[64:67], v18, s[44:47], s83 offen sc1
    buffer_load_dwordx4 v[68:71], v18, s[44:47], s83 offen offset:2048 sc1
    s_mul_i32 s82, s6, 6144
    s_add_u32 s82, s82, 35712
    s_lshl_b32 s65, s7, 11
    s_add_u32 s65, s65, s82
    v_add_u32 v17, s65, v2
    s_mul_i32 s65, s7, 4224
    s_add_u32 s65, s65, s77
    v_add_u32 v20, s65, v2
    s_setprio 2
W35:
    ds_read_b32 v5, v3 offset:18492
    s_waitcnt lgkmcnt(0)
    v_readfirstlane_b32 s64, v5
    s_cmp_ge_u32 s64, 4
    s_cbranch_scc1 D36
    s_sub_u32 s61, s61, 1
    s_cbranch_scc1 BAIL
    s_sleep 1
    s_branch W35
D36:
    ds_write_b128 v14, v[56:59]
    ds_write_b128 v14, v[60:63] offset:4224
    ds_write_b128 v14, v[48:51] offset:2048
    ds_write_b128 v14, v[52:55] offset:6272
    ds_write_b128 v19, a[24:27]
    s_mov_b64 exec, 15
    ds_write_b128 v20, a[24:27] offset:4096
    s_mov_b64 exec, -1
    s_waitcnt vmcnt(0)
    ds_write_b128 v17, v[64:67] offset:512
    ds_write_b128 v17, v[68:71] offset:1536
    s_mov_b64 exec, 1
    ds_add_u32 v6, v4 offset:18464
    s_mov_b64 exec, -1
    v_accvgpr_read_b32 v12, a9
    v_accvgpr_read_b32 v7, a8
    v_accvgpr_read_b32 v16, a10
    v_subrev_u32 v13, 1024, v12
    v_subrev_u32 v14, 2048, v12
    v_subrev_u32 v15, 3072, v12
    s_lshl_b32 s65, s3, 10
    s_add_u32 s69, s65, 48128
    s_mul_i32 s68, s3, 3584
    s_mul_i32 s66, s5, 224
    s_add_u32 s68, s68, s66
    s_lshl_b32 s70, s3, 1
    s_add_u32 s71, s70, 1
    s_min_u32 s71, s71, 6
    s_lshl_b32 s70, s70, 10
    s_lshl_b32 s71, s71, 10
    s_mul_i32 s65, s4, 28672
    s_mul_i32 s66, s5, 7168
    s_add_u32 s65, s65, s66
    s_add_u32 s65, s65, 4718592
    s_add_u32 s70, s70, s65
    s_add_u32 s71, s71, s65
    s_lshl_b32 s65, s4, 2
    s_add_u32 s65, s65, s5
    s_lshl_b32 s65, s65, 13
    s_lshl_b32 s66, s3, 11
    s_add_u32 s65, s65, s66
    s_add_u32 s65, s65, 6553600
    buffer_store_dwordx4 a[28:31], v2, s[44:47], s70 offen sc1
    buffer_store_dwordx4 a[28:31], v2, s[44:47], s71 offen sc1
    buffer_store_dwordx4 a[28:31], v2, s[44:47], s65 offen sc1
    buffer_store_dwordx4 a[28:31], v2, s[44:47], s65 offen offset:1024 sc1
    s_lshl_b32 s65, s5, 2
    s_add_u32 s65, s65, s3
    s_lshl_b32 s65, s65, 6
    s_add_u32 s65, s65, s4
    s_lshl_b32 s65, s65, 6
    s_add_u32 s85, s65, 393216
    s_getreg_b32 s58, hwreg(HW_REG_XCC_ID, 0, 4)
    v_mov_b32 v28, s60
    v_mov_b32 v29, s58
W37:
    ds_read_b32 v5, v6 offset:18464
    s_waitcnt lgkmcnt(0)
    v_readfirstlane_b32 s64, v5
    s_cmp_ge_u32 s64, 2
    s_cbranch_scc1 D38
    s_sub_u32 s61, s61, 1
    s_cbranch_scc1 BAIL
    s_sleep 1
    s_branch W37
D38:
    s_setprio 0
W39:
    ds_read_b32 v5, v3 offset:18448
    s_waitcnt lgkmcnt(0)
    v_readfirstlane_b32 s64, v5
    s_cmp_ge_u32 s64, 4
    s_cbranch_scc1 D40
    s_sub_u32 s61, s61, 1
    s_cbranch_scc1 BAIL
    s_sleep 1
    s_branch W39
D40:
    ds_read2_b32 v[96:97], v12 offset0:176 offset1:177
    ds_read2_b32 v[98:99], v12 offset0:178 offset1:179
    ds_read_b128 v[60:63], v16 offset:3776
    ds_read_b128 v[56:59], v16 offset:3264
    ds_read_b128 v[52:55], v16 offset:2752
    ds_read_b128 v[48:51], v16 offset:2240
    ds_read_b128 v[44:47], v16 offset:1728
    ds_read_b128 v[40:43], v16 offset:1216
    ds_read_b128 v[36:39], v16 offset:704
    ds_read_b128 v[32:35], v16 offset:192
    ds_read2_b32 v[100:101], v12 offset0:48 offset1:49
    ds_read2_b32 v[102:103], v12 offset0:50 offset1:51
    ds_read2_b32 v[104:105], v13 offset0:176 offset1:177
    ds_read2_b32 v[106:107], v13 offset0:178 offset1:179
    s_waitcnt lgkmcnt(11)
    v_mfma_f32_16x16x32_bf16 v[92:95], v[96:99], v[60:63], 0
    ds_read_b128 v[60:63], v16 offset:3712
    ds_read2_b32 v[108:109], v13 offset0:48 offset1:49
    ds_read2_b32 v[110:111], v13 offset0:50 offset1:51
    s_mov_b32 m0, s69
    s_add_u32 s69, s69, 4096
    buffer_load_dwordx4 v7, s[48:51], s68 offen lds
    s_add_u32 s68, s68, 14336
    s_waitcnt lgkmcnt(13)
    v_mfma_f32_16x16x32_bf16 v[88:91], v[96:99], v[56:59], 0
    s_waitcnt lgkmcnt(12)
    v_mfma_f32_16x16x32_bf16 v[84:87], v[96:99], v[52:55], 0
    s_waitcnt lgkmcnt(11)
    v_mfma_f32_16x16x32_bf16 v[80:83], v[96:99], v[48:51], 0
    s_waitcnt lgkmcnt(10)
    v_mfma_f32_16x16x32_bf16 v[76:79], v[96:99], v[44:47], 0
    s_waitcnt lgkmcnt(9)
    v_mfma_f32_16x16x32_bf16 v[72:75], v[96:99], v[40:43], 0
    s_waitcnt lgkmcnt(8)
    v_mfma_f32_16x16x32_bf16 v[68:71], v[96:99], v[36:39], 0
    s_waitcnt lgkmcnt(7)
    v_mfma_f32_16x16x32_bf16 v[64:67], v[96:99], v[32:35], 0
    s_waitcnt lgkmcnt(5)
    v_mfma_f32_16x16x32_bf16 v[92:95], v[100:103], v[56:59], v[92:95]
    ds_read_b128 v[56:59], v16 offset:3200
    ds_read2_b32 v[96:97], v14 offset0:176 offset1:177
    ds_read2_b32 v[98:99], v14 offset0:178 offset1:179
    s_mov_b32 m0, s69
    s_add_u32 s69, s69, 4096
    buffer_load_dwordx4 v7, s[48:51], s68 offen lds
    s_add_u32 s68, s68, 14336
    v_mfma_f32_16x16x32_bf16 v[88:91], v[100:103], v[52:55], v[88:91]
    v_mfma_f32_16x16x32_bf16 v[84:87], v[100:103], v[48:51], v[84:87]
    v_mfma_f32_16x16x32_bf16 v[80:83], v[100:103], v[44:47], v[80:83]
    v_mfma_f32_16x16x32_bf16 v[76:79], v[100:103], v[40:43], v[76:79]
    v_mfma_f32_16x16x32_bf16 v[72:75], v[100:103], v[36:39], v[72:75]
    v_mfma_f32_16x16x32_bf16 v[68:71], v[100:103], v[32:35], v[68:71]
    s_waitcnt lgkmcnt(6)
    v_mfma_f32_16x16x32_bf16 v[92:95], v[104:107], v[52:55], v[92:95]
    ds_read_b128 v[52:55], v16 offset:2688
    ds_read2_b32 v[100:101], v14 offset0:48 offset1:49
    ds_read2_b32 v[102:103], v14 offset0:50 offset1:51
    s_mov_b32 m0, s69
    s_add_u32 s69, s69, 4096
    buffer_load_dwordx4 v7, s[48:51], s68 offen lds
    s_add_u32 s68, s68, 14336
    v_mfma_f32_16x16x32_bf16 v[88:91], v[104:107], v[48:51], v[88:91]
    v_mfma_f32_16x16x32_bf16 v[84:87], v[104:107], v[44:47], v[84:87]
    v_mfma_f32_16x16x32_bf16 v[80:83], v[104:107], v[40:43], v[80:83]
    v_mfma_f32_16x16x32_bf16 v[76:79], v[104:107], v[36:39], v[76:79]
    v_mfma_f32_16x16x32_bf16 v[72:75], v[104:107], v[32:35], v[72:75]
    s_waitcnt lgkmcnt(6)
    v_mfma_f32_16x16x32_bf16 v[92:95], v[108:111], v[48:51], v[92:95]
    ds_read_b128 v[48:51], v16 offset:2176
    ds_read2_b32 v[104:105], v15 offset0:176 offset1:177
    ds_read2_b32 v[106:107], v15 offset0:178 offset1:179
    s_mov_b32 m0, s69
    s_add_u32 s69, s69, 4096
    buffer_load_dwordx4 v7, s[48:51], s68 offen lds
    s_add_u32 s68, s68, 14336
    v_mfma_f32_16x16x32_bf16 v[88:91], v[108:111], v[44:47], v[88:91]
    v_mfma_f32_16x16x32_bf16 v[84:87], v[108:111], v[40:43], v[84:87]
    v_mfma_f32_16x16x32_bf16 v[80:83], v[108:111], v[36:39], v[80:83]
    v_mfma_f32_16x16x32_bf16 v[76:79], v[108:111], v[32:35], v[76:79]
    s_waitcnt lgkmcnt(6)
    v_mfma_f32_16x16x32_bf16 v[92:95], v[96:99], v[44:47], v[92:95]
    ds_read_b128 v[44:47], v16 offset:1664
    ds_read2_b32 v[108:109], v15 offset0:48 offset1:49
    ds_read2_b32 v[110:111], v15 offset0:50 offset1:51
    s_mov_b32 m0, s69
    s_add_u32 s69, s69, 4096
    buffer_load_dwordx4 v7, s[48:51], s68 offen lds
    s_add_u32 s68, s68, 14336
    v_mfma_f32_16x16x32_bf16 v[88:91], v[96:99], v[40:43], v[88:91]
    v_mfma_f32_16x16x32_bf16 v[84:87], v[96:99], v[36:39], v[84:87]
    v_mfma_f32_16x16x32_bf16 v[80:83], v[96:99], v[32:35], v[80:83]
    s_waitcnt lgkmcnt(6)
    v_mfma_f32_16x16x32_bf16 v[92:95], v[100:103], v[40:43], v[92:95]
    ds_read_b128 v[40:43], v16 offset:1152
    ds_read2_b32 v[96:97], v12 offset0:160 offset1:161
    ds_read2_b32 v[98:99], v12 offset0:162 offset1:163
    s_mov_b32 m0, s69
    s_add_u32 s69, s69, 4096
    buffer_load_dwordx4 v7, s[48:51], s68 offen lds
    s_add_u32 s68, s68, 14336
    v_mfma_f32_16x16x32_bf16 v[88:91], v[100:103], v[36:39], v[88:91]
    v_mfma_f32_16x16x32_bf16 v[84:87], v[100:103], v[32:35], v[84:87]
    s_waitcnt lgkmcnt(6)
    v_mfma_f32_16x16x32_bf16 v[92:95], v[104:107], v[36:39], v[92:95]
    ds_read_b128 v[36:39], v16 offset:640
    ds_read2_b32 v[100:101], v12 offset0:32 offset1:33
    ds_read2_b32 v[102:103], v12 offset0:34 offset1:35
    s_mov_b32 m0, s69
    s_add_u32 s69, s69, 4096
    buffer_load_dwordx4 v7, s[48:51], s68 offen lds
    s_add_u32 s68, s68, 14336
    v_mfma_f32_16x16x32_bf16 v[88:91], v[104:107], v[32:35], v[88:91]
    s_waitcnt lgkmcnt(6)
    v_mfma_f32_16x16x32_bf16 v[92:95], v[108:111], v[32:35], v[92:95]
    ds_read_b128 v[32:35], v16 offset:128
    ds_read2_b32 v[104:105], v13 offset0:160 offset1:161
    ds_read2_b32 v[106:107], v13 offset0:162 offset1:163
    s_waitcnt vmcnt(7)
    s_mov_b64 exec, 1
    buffer_store_dwordx2 v[28:29], v3, s[44:47], s85 offen sc1
    s_mov_b64 exec, -1
    s_waitcnt lgkmcnt(6)
    v_mfma_f32_16x16x32_bf16 v[92:95], v[96:99], v[60:63], v[92:95]
    ds_read_b128 v[60:63], v16 offset:3648
    ds_read2_b32 v[108:109], v13 offset0:32 offset1:33
    ds_read2_b32 v[110:111], v13 offset0:34 offset1:35
    s_mov_b32 m0, s69
    s_add_u32 s69, s69, 4096
    buffer_load_dwordx4 v7, s[48:51], s68 offen lds
    s_add_u32 s68, s68, 14336
    v_mfma_f32_16x16x32_bf16 v[88:91], v[96:99], v[56:59], v[88:91]
    v_mfma_f32_16x16x32_bf16 v[84:87], v[96:99], v[52:55], v[84:87]
    v_mfma_f32_16x16x32_bf16 v[80:83], v[96:99], v[48:51], v[80:83]
    s_waitcnt lgkmcnt(14)
    v_mfma_f32_16x16x32_bf16 v[76:79], v[96:99], v[44:47], v[76:79]
    s_waitcnt lgkmcnt(11)
    v_mfma_f32_16x16x32_bf16 v[72:75], v[96:99], v[40:43], v[72:75]
    s_waitcnt lgkmcnt(8)
    v_mfma_f32_16x16x32_bf16 v[68:71], v[96:99], v[36:39], v[68:71]
    s_waitcnt lgkmcnt(5)
    v_mfma_f32_16x16x32_bf16 v[64:67], v[96:99], v[32:35], v[64:67]
    s_waitcnt lgkmcnt(6)
    v_mfma_f32_16x16x32_bf16 v[92:95], v[100:103], v[56:59], v[92:95]
    ds_read_b128 v[56:59], v16 offset:3136
    ds_read2_b32 v[96:97], v14 offset0:160 offset1:161
    ds_read2_b32 v[98:99], v14 offset0:162 offset1:163
    s_mov_b32 m0, s69
    s_add_u32 s69, s69, 4096
    buffer_load_dwordx4 v7, s[48:51], s68 offen lds
    s_add_u32 s68, s68, 14336
    v_mfma_f32_16x16x32_bf16 v[88:91], v[100:103], v[52:55], v[88:91]
    v_mfma_f32_16x16x32_bf16 v[84:87], v[100:103], v[48:51], v[84:87]
    v_mfma_f32_16x16x32_bf16 v[80:83], v[100:103], v[44:47], v[80:83]
    v_mfma_f32_16x16x32_bf16 v[76:79], v[100:103], v[40:43], v[76:79]
    v_mfma_f32_16x16x32_bf16 v[72:75], v[100:103], v[36:39], v[72:75]
    v_mfma_f32_16x16x32_bf16 v[68:71], v[100:103], v[32:35], v[68:71]
    s_waitcnt lgkmcnt(6)
    v_mfma_f32_16x16x32_bf16 v[92:95], v[104:107], v[52:55], v[92:95]
    ds_read_b128 v[52:55], v16 offset:2624
    ds_read2_b32 v[100:101], v14 offset0:32 offset1:33
    ds_read2_b32 v[102:103], v14 offset0:34 offset1:35
    s_mov_b32 m0, s69
    s_add_u32 s69, s69, 4096
    buffer_load_dwordx4 v7, s[48:51], s68 offen lds
    s_add_u32 s68, s68, 14336
    v_mfma_f32_16x16x32_bf16 v[88:91], v[104:107], v[48:51], v[88:91]
    v_mfma_f32_16x16x32_bf16 v[84:87], v[104:107], v[44:47], v[84:87]
    v_mfma_f32_16x16x32_bf16 v[80:83], v[104:107], v[40:43], v[80:83]
    v_mfma_f32_16x16x32_bf16 v[76:79], v[104:107], v[36:39], v[76:79]
    v_mfma_f32_16x16x32_bf16 v[72:75], v[104:107], v[32:35], v[72:75]
    s_waitcnt lgkmcnt(6)
    v_mfma_f32_16x16x32_bf16 v[92:95], v[108:111], v[48:51], v[92:95]
    ds_read_b128 v[48:51], v16 offset:2112
    ds_read2_b32 v[104:105], v15 offset0:160 offset1:161
    ds_read2_b32 v[106:107], v15 offset0:162 offset1:163
    s_mov_b32 m0, s69
    s_add_u32 s69, s69, 4096
    buffer_load_dwordx4 v7, s[48:51], s68 offen lds
    s_add_u32 s68, s68, 14336
    v_mfma_f32_16x16x32_bf16 v[88:91], v[108:111], v[44:47], v[88:91]
    v_mfma_f32_16x16x32_bf16 v[84:87], v[108:111], v[40:43], v[84:87]
    v_mfma_f32_16x16x32_bf16 v[80:83], v[108:111], v[36:39], v[80:83]
    v_mfma_f32_16x16x32_bf16 v[76:79], v[108:111], v[32:35], v[76:79]
    s_waitcnt lgkmcnt(6)
    v_mfma_f32_16x16x32_bf16 v[92:95], v[96:99], v[44:47], v[92:95]
    ds_read_b128 v[44:47], v16 offset:1600
    ds_read2_b32 v[108:109], v15 offset0:32 offset1:33
    ds_read2_b32 v[110:111], v15 offset0:34 offset1:35
    s_mov_b32 m0, s69
    s_add_u32 s69, s69, 4096
    buffer_load_dwordx4 v7, s[48:51], s68 offen lds
    s_add_u32 s68, s68, 14336
    v_mfma_f32_16x16x32_bf16 v[88:91], v[96:99], v[40:43], v[88:91]
    v_mfma_f32_16x16x32_bf16 v[84:87], v[96:99], v[36:39], v[84:87]
    v_mfma_f32_16x16x32_bf16 v[80:83], v[96:99], v[32:35], v[80:83]
    s_waitcnt lgkmcnt(6)
    v_mfma_f32_16x16x32_bf16 v[92:95], v[100:103], v[40:43], v[92:95]
    ds_read_b128 v[40:43], v16 offset:1088
    ds_read2_b32 v[96:97], v12 offset0:144 offset1:145
    ds_read2_b32 v[98:99], v12 offset0:146 offset1:147
    s_mov_b32 m0, s69
    s_add_u32 s69, s69, 4096
    buffer_load_dwordx4 v7, s[48:51], s68 offen lds
    s_add_u32 s68, s68, 14336
    v_mfma_f32_16x16x32_bf16 v[88:91], v[100:103], v[36:39], v[88:91]
    v_mfma_f32_16x16x32_bf16 v[84:87], v[100:103], v[32:35], v[84:87]
    s_waitcnt lgkmcnt(6)
    v_mfma_f32_16x16x32_bf16 v[92:95], v[104:107], v[36:39], v[92:95]
    ds_read_b128 v[36:39], v16 offset:576
    ds_read2_b32 v[100:101], v12 offset0:16 offset1:17
    ds_read2_b32 v[102:103], v12 offset0:18 offset1:19
    s_mov_b32 m0, s69
    s_add_u32 s69, s69, 4096
    buffer_load_dwordx4 v7, s[48:51], s68 offen lds
    s_add_u32 s68, s68, 14336
    v_mfma_f32_16x16x32_bf16 v[88:91], v[104:107], v[32:35], v[88:91]
    s_waitcnt lgkmcnt(6)
    v_mfma_f32_16x16x32_bf16 v[92:95], v[108:111], v[32:35], v[92:95]
    ds_read_b128 v[32:35], v16 offset:64
    ds_read2_b32 v[104:105], v13 offset0:144 offset1:145
    ds_read2_b32 v[106:107], v13 offset0:146 offset1:147
    s_waitcnt lgkmcnt(6)
    v_mfma_f32_16x16x32_bf16 v[92:95], v[96:99], v[60:63], v[92:95]
    ds_read_b128 v[60:63], v16 offset:3584
    ds_read2_b32 v[108:109], v13 offset0:16 offset1:17
    ds_read2_b32 v[110:111], v13 offset0:18 offset1:19
    s_mov_b32 m0, s69
    s_add_u32 s69, s69, 4096
    buffer_load_dwordx4 v7, s[48:51], s68 offen lds
    s_add_u32 s68, s68, 14336
    v_mfma_f32_16x16x32_bf16 v[88:91], v[96:99], v[56:59], v[88:91]
    v_mfma_f32_16x16x32_bf16 v[84:87], v[96:99], v[52:55], v[84:87]
    v_mfma_f32_16x16x32_bf16 v[80:83], v[96:99], v[48:51], v[80:83]
    s_waitcnt lgkmcnt(14)
    v_mfma_f32_16x16x32_bf16 v[76:79], v[96:99], v[44:47], v[76:79]
    s_waitcnt lgkmcnt(11)
    v_mfma_f32_16x16x32_bf16 v[72:75], v[96:99], v[40:43], v[72:75]
    s_waitcnt lgkmcnt(8)
    v_mfma_f32_16x16x32_bf16 v[68:71], v[96:99], v[36:39], v[68:71]
    s_waitcnt lgkmcnt(5)
    v_mfma_f32_16x16x32_bf16 v[64:67], v[96:99], v[32:35], v[64:67]
    s_waitcnt lgkmcnt(6)
    v_mfma_f32_16x16x32_bf16 v[92:95], v[100:103], v[56:59], v[92:95]
    ds_read_b128 v[56:59], v16 offset:3072
    ds_read2_b32 v[96:97], v14 offset0:144 offset1:145
    ds_read2_b32 v[98:99], v14 offset0:146 offset1:147
    s_mov_b32 m0, s69
    s_add_u32 s69, s69, 4096
    buffer_load_dwordx4 v7, s[48:51], s68 offen lds
    s_add_u32 s68, s68, 14336
    v_mfma_f32_16x16x32_bf16 v[88:91], v[100:103], v[52:55], v[88:91]
    v_mfma_f32_16x16x32_bf16 v[84:87], v[100:103], v[48:51], v[84:87]
    v_mfma_f32_16x16x32_bf16 v[80:83], v[100:103], v[44:47], v[80:83]
    v_mfma_f32_16x16x32_bf16 v[76:79], v[100:103], v[40:43], v[76:79]
    v_mfma_f32_16x16x32_bf16 v[72:75], v[100:103], v[36:39], v[72:75]
    v_mfma_f32_16x16x32_bf16 v[68:71], v[100:103], v[32:35], v[68:71]
    s_waitcnt lgkmcnt(6)
    v_mfma_f32_16x16x32_bf16 v[92:95], v[104:107], v[52:55], v[92:95]
    ds_read_b128 v[52:55], v16 offset:2560
    ds_read2_b32 v[100:101], v14 offset0:16 offset1:17
    ds_read2_b32 v[102:103], v14 offset0:18 offset1:19
    s_mov_b32 m0, s69
    s_add_u32 s69, s69, 4096
    buffer_load_dwordx4 v7, s[48:51], s68 offen lds
    s_add_u32 s68, s68, 14336
    v_mfma_f32_16x16x32_bf16 v[88:91], v[104:107], v[48:51], v[88:91]
    v_mfma_f32_16x16x32_bf16 v[84:87], v[104:107], v[44:47], v[84:87]
    v_mfma_f32_16x16x32_bf16 v[80:83], v[104:107], v[40:43], v[80:83]
    v_mfma_f32_16x16x32_bf16 v[76:79], v[104:107], v[36:39], v[76:79]
    v_mfma_f32_16x16x32_bf16 v[72:75], v[104:107], v[32:35], v[72:75]
    s_waitcnt lgkmcnt(6)
    v_mfma_f32_16x16x32_bf16 v[92:95], v[108:111], v[48:51], v[92:95]
    ds_read_b128 v[48:51], v16 offset:2048
    ds_read2_b32 v[104:105], v15 offset0:144 offset1:145
    ds_read2_b32 v[106:107], v15 offset0:146 offset1:147
    s_mov_b32 m0, s69
    s_add_u32 s69, s69, 4096
    buffer_load_dwordx4 v7, s[48:51], s68 offen lds
    s_add_u32 s68, s68, 14336
    v_mfma_f32_16x16x32_bf16 v[88:91], v[108:111], v[44:47], v[88:91]
    v_mfma_f32_16x16x32_bf16 v[84:87], v[108:111], v[40:43], v[84:87]
    v_mfma_f32_16x16x32_bf16 v[80:83], v[108:111], v[36:39], v[80:83]
    v_mfma_f32_16x16x32_bf16 v[76:79], v[108:111], v[32:35], v[76:79]
    s_waitcnt lgkmcnt(6)
    v_mfma_f32_16x16x32_bf16 v[92:95], v[96:99], v[44:47], v[92:95]
    ds_read_b128 v[44:47], v16 offset:1536
    ds_read2_b32 v[108:109], v15 offset0:16 offset1:17
    ds_read2_b32 v[110:111], v15 offset0:18 offset1:19
    s_mov_b32 m0, s69
    s_add_u32 s69, s69, 4096
    buffer_load_dwordx4 v7, s[48:51], s68 offen lds
    s_add_u32 s68, s68, 14336
    v_mfma_f32_16x16x32_bf16 v[88:91], v[96:99], v[40:43], v[88:91]
    v_mfma_f32_16x16x32_bf16 v[84:87], v[96:99], v[36:39], v[84:87]
    v_mfma_f32_16x16x32_bf16 v[80:83], v[96:99], v[32:35], v[80:83]
    s_waitcnt lgkmcnt(6)
    v_mfma_f32_16x16x32_bf16 v[92:95], v[100:103], v[40:43], v[92:95]
    ds_read_b128 v[40:43], v16 offset:1024
    ds_read2_b32 v[96:97], v12 offset0:128 offset1:129
    ds_read2_b32 v[98:99], v12 offset0:130 offset1:131
    s_mov_b32 m0, s69
    s_add_u32 s69, s69, 4096
    buffer_load_dwordx4 v7, s[48:51], s68 offen lds
    s_add_u32 s68, s68, 14336
    v_mfma_f32_16x16x32_bf16 v[88:91], v[100:103], v[36:39], v[88:91]
    v_mfma_f32_16x16x32_bf16 v[84:87], v[100:103], v[32:35], v[84:87]
    s_waitcnt lgkmcnt(6)
    v_mfma_f32_16x16x32_bf16 v[92:95], v[104:107], v[36:39], v[92:95]
    ds_read_b128 v[36:39], v16 offset:512
    ds_read2_b32 v[100:101], v12 offset0:0 offset1:1
    ds_read2_b32 v[102:103], v12 offset0:2 offset1:3
    s_mov_b32 m0, s69
    s_add_u32 s69, s69, 4096
    buffer_load_dwordx4 v7, s[48:51], s68 offen lds
    s_add_u32 s68, s68, 14336
    v_mfma_f32_16x16x32_bf16 v[88:91], v[104:107], v[32:35], v[88:91]
    s_waitcnt lgkmcnt(6)
    v_mfma_f32_16x16x32_bf16 v[92:95], v[108:111], v[32:35], v[92:95]
    ds_read_b128 v[32:35], v16 offset:0
    ds_read2_b32 v[104:105], v13 offset0:128 offset1:129
    ds_read2_b32 v[106:107], v13 offset0:130 offset1:131
    s_waitcnt lgkmcnt(6)
    v_mfma_f32_16x16x32_bf16 v[92:95], v[96:99], v[60:63], v[92:95]
    ds_read2_b32 v[108:109], v13 offset0:0 offset1:1
    ds_read2_b32 v[110:111], v13 offset0:2 offset1:3
    s_mov_b32 m0, s69
    s_add_u32 s69, s69, 4096
    buffer_load_dwordx4 v7, s[48:51], s68 offen lds
    s_add_u32 s68, s68, 14336
    v_mfma_f32_16x16x32_bf16 v[88:91], v[96:99], v[56:59], v[88:91]
    v_mfma_f32_16x16x32_bf16 v[84:87], v[96:99], v[52:55], v[84:87]
    v_mfma_f32_16x16x32_bf16 v[80:83], v[96:99], v[48:51], v[80:83]
    s_waitcnt lgkmcnt(13)
    v_mfma_f32_16x16x32_bf16 v[76:79], v[96:99], v[44:47], v[76:79]
    s_waitcnt lgkmcnt(10)
    v_mfma_f32_16x16x32_bf16 v[72:75], v[96:99], v[40:43], v[72:75]
    s_waitcnt lgkmcnt(7)
    v_mfma_f32_16x16x32_bf16 v[68:71], v[96:99], v[36:39], v[68:71]
    s_waitcnt lgkmcnt(4)
    v_mfma_f32_16x16x32_bf16 v[64:67], v[96:99], v[32:35], v[64:67]
    s_waitcnt lgkmcnt(5)
    v_mfma_f32_16x16x32_bf16 v[92:95], v[100:103], v[56:59], v[92:95]
    ds_read2_b32 v[96:97], v14 offset0:128 offset1:129
    ds_read2_b32 v[98:99], v14 offset0:130 offset1:131
    s_mov_b32 m0, s69
    s_add_u32 s69, s69, 4096
    buffer_load_dwordx4 v7, s[48:51], s68 offen lds
    s_add_u32 s68, s68, 14336
    v_mfma_f32_16x16x32_bf16 v[88:91], v[100:103], v[52:55], v[88:91]
    v_mfma_f32_16x16x32_bf16 v[84:87], v[100:103], v[48:51], v[84:87]
    v_mfma_f32_16x16x32_bf16 v[80:83], v[100:103], v[44:47], v[80:83]
    v_mfma_f32_16x16x32_bf16 v[76:79], v[100:103], v[40:43], v[76:79]
    v_mfma_f32_16x16x32_bf16 v[72:75], v[100:103], v[36:39], v[72:75]
    v_mfma_f32_16x16x32_bf16 v[68:71], v[100:103], v[32:35], v[68:71]
    s_waitcnt lgkmcnt(4)
    v_mfma_f32_16x16x32_bf16 v[92:95], v[104:107], v[52:55], v[92:95]
    ds_read2_b32 v[100:101], v14 offset0:0 offset1:1
    ds_read2_b32 v[102:103], v14 offset0:2 offset1:3
    s_mov_b32 m0, s69
    s_add_u32 s69, s69, 4096
    buffer_load_dwordx4 v7, s[48:51], s68 offen lds
    s_add_u32 s68, s68, 14336
    v_mfma_f32_16x16x32_bf16 v[88:91], v[104:107], v[48:51], v[88:91]
    v_mfma_f32_16x16x32_bf16 v[84:87], v[104:107], v[44:47], v[84:87]
    v_mfma_f32_16x16x32_bf16 v[80:83], v[104:107], v[40:43], v[80:83]
    v_mfma_f32_16x16x32_bf16 v[76:79], v[104:107], v[36:39], v[76:79]
    v_mfma_f32_16x16x32_bf16 v[72:75], v[104:107], v[32:35], v[72:75]
    s_waitcnt lgkmcnt(4)
    v_mfma_f32_16x16x32_bf16 v[92:95], v[108:111], v[48:51], v[92:95]
    ds_read2_b32 v[104:105], v15 offset0:128 offset1:129
    ds_read2_b32 v[106:107], v15 offset0:130 offset1:131
    s_mov_b32 m0, s69
    s_add_u32 s69, s69, 4096
    buffer_load_dwordx4 v7, s[48:51], s68 offen lds
    s_add_u32 s68, s68, 14336
    v_mfma_f32_16x16x32_bf16 v[88:91], v[108:111], v[44:47], v[88:91]
    v_mfma_f32_16x16x32_bf16 v[84:87], v[108:111], v[40:43], v[84:87]
    v_mfma_f32_16x16x32_bf16 v[80:83], v[108:111], v[36:39], v[80:83]
    v_mfma_f32_16x16x32_bf16 v[76:79], v[108:111], v[32:35], v[76:79]
    s_waitcnt lgkmcnt(4)
    v_mfma_f32_16x16x32_bf16 v[92:95], v[96:99], v[44:47], v[92:95]
    ds_read2_b32 v[108:109], v15 offset0:0 offset1:1
    ds_read2_b32 v[110:111], v15 offset0:2 offset1:3
    s_mov_b32 m0, s69
    s_add_u32 s69, s69, 4096
    buffer_load_dwordx4 v7, s[48:51], s68 offen lds
    s_add_u32 s68, s68, 14336
    v_mfma_f32_16x16x32_bf16 v[88:91], v[96:99], v[40:43], v[88:91]
    v_mfma_f32_16x16x32_bf16 v[84:87], v[96:99], v[36:39], v[84:87]
    v_mfma_f32_16x16x32_bf16 v[80:83], v[96:99], v[32:35], v[80:83]
    s_waitcnt lgkmcnt(4)
    v_mfma_f32_16x16x32_bf16 v[92:95], v[100:103], v[40:43], v[92:95]
    s_mov_b32 m0, s69
    s_add_u32 s69, s69, 4096
    buffer_load_dwordx4 v7, s[48:51], s68 offen lds
    s_add_u32 s68, s68, 14336
    v_mfma_f32_16x16x32_bf16 v[88:91], v[100:103], v[36:39], v[88:91]
    v_mfma_f32_16x16x32_bf16 v[84:87], v[100:103], v[32:35], v[84:87]
    s_waitcnt lgkmcnt(2)
    v_mfma_f32_16x16x32_bf16 v[92:95], v[104:107], v[36:39], v[92:95]
    s_mov_b32 m0, s69
    s_add_u32 s69, s69, 4096
    buffer_load_dwordx4 v7, s[48:51], s68 offen lds
    s_add_u32 s68, s68, 14336
    v_mfma_f32_16x16x32_bf16 v[88:91], v[104:107], v[32:35], v[88:91]
    s_waitcnt lgkmcnt(0)
    v_mfma_f32_16x16x32_bf16 v[92:95], v[108:111], v[32:35], v[92:95]
    v_lshlrev_b32 v29, 6, v1
    buffer_load_dword v30, v29, s[44:47], s84 offen sc1
    s_setprio 1
    s_mul_i32 s65, s3, 4608
    v_add_u32 v8, s65, v2
    s_xor_b32 s65, s3, 1
    s_mul_i32 s65, s65, 4608
    v_add_u32 v9, s65, v2
    s_waitcnt lgkmcnt(0)
    s_nop 7
    s_cmp_eq_u32 s7, 0
    s_cbranch_scc1 H_C0
    ds_write_b128 v8, v[64:67] offset:0
    ds_write_b128 v8, v[68:71] offset:1024
    ds_write_b128 v8, v[72:75] offset:2048
    ds_write_b128 v8, v[76:79] offset:3072
    s_branch H_C1
H_C0:
    ds_write_b128 v8, v[80:83] offset:0
    ds_write_b128 v8, v[84:87] offset:1024
    ds_write_b128 v8, v[88:91] offset:2048
    ds_write_b128 v8, v[92:95] offset:3072
H_C1:
    s_mov_b64 exec, 1
    ds_add_u32 v6, v4 offset:18472
    s_mov_b64 exec, -1
W41:
    ds_read_b32 v5, v6 offset:18472
    s_waitcnt lgkmcnt(0)
    v_readfirstlane_b32 s64, v5
    s_cmp_ge_u32 s64, 2
    s_cbranch_scc1 D42
    s_sub_u32 s61, s61, 1
    s_cbranch_scc1 BAIL
    s_sleep 2
    s_branch W41
D42:
    ds_read_b128 v[32:35], v9 offset:0
    ds_read_b128 v[36:39], v9 offset:1024
    ds_read_b128 v[40:43], v9 offset:2048
    ds_read_b128 v[44:47], v9 offset:3072
    v_accvgpr_read_b32 v8, a11
    s_lshl_b32 s65, s76, 1
    s_add_u32 s65, s65, s6
    s_lshl_b32 s65, s65, 6
    s_mul_i32 s66, s7, 917504
    s_add_u32 s65, s65, s66
    s_add_u32 s65, s65, 4718592
    s_add_u32 s66, s65, 458752
    s_mov_b32 s75, 0xfffffffe
    s_cmp_eq_u32 s7, 0
    s_waitcnt lgkmcnt(0)
    s_cbranch_scc1 H_A0
    v_add_f32 v48, v80, v32
    v_add_f32 v49, v81, v33
    v_add_f32 v50, v82, v34
    v_add_f32 v51, v83, v35
    v_add_f32 v52, v84, v36
    v_add_f32 v53, v85, v37
    v_add_f32 v54, v86, v38
    v_add_f32 v55, v87, v39
    v_add_f32 v56, v88, v40
    v_add_f32 v57, v89, v41
    v_add_f32 v58, v90, v42
    v_add_f32 v59, v91, v43
    v_add_f32 v60, v92, v44
    v_add_f32 v61, v93, v45
    v_add_f32 v62, v94, v46
    v_add_f32 v63, v95, v47
    s_branch H_A1
H_A0:
    v_add_f32 v48, v64, v32
    v_add_f32 v49, v65, v33
    v_add_f32 v50, v66, v34
    v_add_f32 v51, v67, v35
    v_add_f32 v52, v68, v36
    v_add_f32 v53, v69, v37
    v_add_f32 v54, v70, v38
    v_add_f32 v55, v71, v39
    v_add_f32 v56, v72, v40
    v_add_f32 v57, v73, v41
    v_add_f32 v58, v74, v42
    v_add_f32 v59, v75, v43
    v_add_f32 v60, v76, v44
    v_add_f32 v61, v77, v45
    v_add_f32 v62, v78, v46
    v_add_f32 v63, v79, v47
H_A1:
    v_cvt_pk_bf16_f32 v32, v48, v49
    v_cvt_pk_bf16_f32 v33, v50, v51
    v_cvt_pk_bf16_f32 v34, v52, v53
    v_cvt_pk_bf16_f32 v35, v54, v55
    v_cvt_pk_bf16_f32 v36, v56, v57
    v_cvt_pk_bf16_f32 v37, v58, v59
    v_cvt_pk_bf16_f32 v38, v60, v61
    v_cvt_pk_bf16_f32 v39, v62, v63
    s_cmp_ge_u32 s2, 224
    s_nop 0
    v_permlane16_swap_b32 v32, v34
    v_permlane16_swap_b32 v33, v35
    v_permlane16_swap_b32 v36, v38
    v_permlane16_swap_b32 v37, v39
    v_min_u32 v32, s75, v32
    v_min_u32 v36, s75, v36
    s_cbranch_scc1 H_NOBT
    s_waitcnt vmcnt(0)
H_FCP:
    v_cmp_ne_u32 vcc, s60, v30
    s_cbranch_vccz H_FCOK
    s_sub_u32 s61, s61, 1
    s_cbranch_scc1 BAIL
    buffer_load_dword v30, v29, s[44:47], s84 offen sc1
    s_waitcnt vmcnt(0)
    s_branch H_FCP
H_FCOK:
    buffer_store_dwordx4 v[32:35], v8, s[44:47], s65 offen sc1
    buffer_store_dwordx4 v[36:39], v8, s[44:47], s66 offen sc1
H_NOBT:
    v_and_b32 v28, 0x7c0, v29
    s_lshl_b32 s80, s3, 11
    s_add_u32 s80, s80, 262144
    buffer_load_dwordx2 v[30:31], v28, s[44:47], s80 offen sc1
    v_and_b32 v29, 15, v1
    v_lshlrev_b32 v29, 12, v29
    s_lshl_b32 s84, s4, 6
    s_add_u32 s84, s84, 393216
    buffer_load_dwordx2 v[18:19], v29, s[44:47], s84 offen sc1
    v_accvgpr_read_b32 v9, a12
    v_accvgpr_read_b32 v8, a13
    v_accvgpr_read_b32 v12, a14
    s_add_u32 s65, s5, 0
    s_and_b32 s65, s65, 3
    s_mul_i32 s65, s65, 28672
    s_add_u32 s65, s65, 48128
    v_add_u32 v24, s65, v9
    s_add_u32 s65, s5, 1
    s_and_b32 s65, s65, 3
    s_mul_i32 s65, s65, 28672
    s_add_u32 s65, s65, 48128
    v_add_u32 v25, s65, v9
    s_add_u32 s65, s5, 2
    s_and_b32 s65, s65, 3
    s_mul_i32 s65, s65, 28672
    s_add_u32 s65, s65, 48128
    v_add_u32 v26, s65, v9
    s_add_u32 s65, s5, 3
    s_and_b32 s65, s65, 3
    s_mul_i32 s65, s65, 28672
    s_add_u32 s65, s65, 48128
    v_add_u32 v27, s65, v9
    v_lshlrev_b32 v13, 2, v1
    ds_read_b32 v15, v13 offset:18560
    s_waitcnt vmcnt(0)
    s_mov_b64 exec, 1
    ds_add_u32 v3, v4 offset:18480
    s_mov_b64 exec, -1
H_KN:
    v_cmp_ne_u32 vcc, s60, v30
    v_cmp_ne_u32 s[70:71], s60, v18
    s_or_b64 vcc, vcc, s[70:71]
    s_cbranch_vccz H_KNOK
    s_sub_u32 s61, s61, 1
    s_cbranch_scc1 BAIL
    buffer_load_dwordx2 v[30:31], v28, s[44:47], s80 offen sc1
    buffer_load_dwordx2 v[18:19], v29, s[44:47], s84 offen sc1
    s_waitcnt vmcnt(0)
    s_branch H_KN
H_KNOK:
    v_cmp_ne_u32 vcc, s58, v19
    s_nop 1
    s_cmp_lg_u64 vcc, 0
    s_cselect_b32 s59, 1, 0
    s_mov_b32 exec_hi, 0
    ds_max_u32 v3, v31 offset:18532
    s_mov_b32 exec_hi, -1
W43:
    ds_read_b32 v5, v3 offset:18480
    s_waitcnt lgkmcnt(0)
    v_readfirstlane_b32 s64, v5
    s_cmp_ge_u32 s64, 4
    s_cbranch_scc1 D44
    s_sub_u32 s61, s61, 1
    s_cbranch_scc1 BAIL
    s_sleep 2
    s_branch W43
D44:
    ds_read_b64_tr_b16 a[0:1], v24 offset:0
    ds_read_b64_tr_b16 a[2:3], v24 offset:2048
    ds_read_b64_tr_b16 a[4:5], v24 offset:4096
    ds_read_b64_tr_b16 a[6:7], v24 offset:6144
    ds_read_b64_tr_b16 a[8:9], v24 offset:7168
    ds_read_b64_tr_b16 a[10:11], v24 offset:9216
    ds_read_b64_tr_b16 a[12:13], v24 offset:11264
    ds_read_b64_tr_b16 a[14:15], v24 offset:13312
    ds_read_b64_tr_b16 a[16:17], v24 offset:14336
    ds_read_b64_tr_b16 a[18:19], v24 offset:16384
    ds_read_b64_tr_b16 a[20:21], v24 offset:18432
    ds_read_b64_tr_b16 a[22:23], v24 offset:20480
    ds_read_b64_tr_b16 a[24:25], v24 offset:21504
    ds_read_b64_tr_b16 a[26:27], v24 offset:23552
    ds_read_b64_tr_b16 a[28:29], v24 offset:25600
    ds_read_b64_tr_b16 a[30:31], v24 offset:27648
    ds_read_b64_tr_b16 a[32:33], v25 offset:0
    ds_read_b64_tr_b16 a[34:35], v25 offset:2048
    ds_read_b64_tr_b16 a[36:37], v25 offset:4096
    ds_read_b64_tr_b16 a[38:39], v25 offset:6144
    ds_read_b64_tr_b16 a[40:41], v25 offset:7168
    ds_read_b64_tr_b16 a[42:43], v25 offset:9216
    ds_read_b64_tr_b16 a[44:45], v25 offset:11264
    ds_read_b64_tr_b16 a[46:47], v25 offset:13312
    ds_read_b64_tr_b16 a[48:49], v25 offset:14336
    ds_read_b64_tr_b16 a[50:51], v25 offset:16384
    ds_read_b64_tr_b16 a[52:53], v25 offset:18432
    ds_read_b64_tr_b16 a[54:55], v25 offset:20480
    ds_read_b64_tr_b16 a[56:57], v25 offset:21504
    ds_read_b64_tr_b16 a[58:59], v25 offset:23552
    ds_read_b64_tr_b16 a[60:61], v25 offset:25600
    ds_read_b64_tr_b16 a[62:63], v25 offset:27648
    ds_read_b64_tr_b16 a[64:65], v26 offset:0
    ds_read_b64_tr_b16 a[66:67], v26 offset:2048
    ds_read_b64_tr_b16 a[68:69], v26 offset:4096
    ds_read_b64_tr_b16 a[70:71], v26 offset:6144
    ds_read_b64_tr_b16 a[72:73], v26 offset:7168
    ds_read_b64_tr_b16 a[74:75], v26 offset:9216
    ds_read_b64_tr_b16 a[76:77], v26 offset:11264
    ds_read_b64_tr_b16 a[78:79], v26 offset:13312
    ds_read_b64_tr_b16 a[80:81], v26 offset:14336
    ds_read_b64_tr_b16 a[82:83], v26 offset:16384
    ds_read_b64_tr_b16 a[84:85], v26 offset:18432
    ds_read_b64_tr_b16 a[86:87], v26 offset:20480
    ds_read_b64_tr_b16 a[88:89], v26 offset:21504
    ds_read_b64_tr_b16 a[90:91], v26 offset:23552
    ds_read_b64_tr_b16 a[92:93], v26 offset:25600
    ds_read_b64_tr_b16 a[94:95], v26 offset:27648
    ds_read_b64_tr_b16 a[96:97], v27 offset:0
    ds_read_b64_tr_b16 a[98:99], v27 offset:2048
    ds_read_b64_tr_b16 a[100:101], v27 offset:4096
    ds_read_b64_tr_b16 a[102:103], v27 offset:6144
    ds_read_b64_tr_b16 a[104:105], v27 offset:7168
    ds_read_b64_tr_b16 a[106:107], v27 offset:9216
    ds_read_b64_tr_b16 a[108:109], v27 offset:11264
    ds_read_b64_tr_b16 a[110:111], v27 offset:13312
    ds_read_b64_tr_b16 a[112:113], v27 offset:14336
    ds_read_b64_tr_b16 a[114:115], v27 offset:16384
    ds_read_b64_tr_b16 a[116:117], v27 offset:18432
    ds_read_b64_tr_b16 a[118:119], v27 offset:20480
    ds_read_b64_tr_b16 a[120:121], v27 offset:21504
    ds_read_b64_tr_b16 a[122:123], v27 offset:23552
    ds_read_b64_tr_b16 a[124:125], v27 offset:25600
    ds_read_b64_tr_b16 a[126:127], v27 offset:27648
    v_sub_f32 v9, 1.0, v15
    v_and_b32 v10, 4, v13
    v_cvt_pk_bf16_f32 v9, v9, 0
    v_lshlrev_b32 v10, 2, v10
    v_lshlrev_b32 v9, v10, v9
    v_cndmask_b32 v40, 0, v9, s[20:21]
    v_cndmask_b32 v41, 0, v9, s[22:23]
    v_cndmask_b32 v42, 0, v9, s[24:25]
    v_cndmask_b32 v43, 0, v9, s[26:27]
    v_cndmask_b32 v44, 0, v9, s[28:29]
    v_cndmask_b32 v45, 0, v9, s[30:31]
    v_cndmask_b32 v46, 0, v9, s[32:33]
    v_cndmask_b32 v47, 0, v9, s[34:35]
    s_mul_i32 s65, s4, 28672
    s_mul_i32 s66, s5, 7168
    s_add_u32 s65, s65, s66
    s_lshl_b32 s66, s3, 11
    s_add_u32 s65, s65, s66
    s_add_u32 s65, s65, 4718592
    s_mul_i32 s66, s4, 28672
    s_mul_i32 s67, s5, 224
    s_add_u32 s66, s66, s67
    s_lshl_b32 s67, s3, 6
    s_add_u32 s66, s66, s67
    v_add_u32 v14, 101376, v2
    s_cmp_eq_u32 s3, 3
    s_cselect_b32 s70, 0xffff, -1
    s_mov_b32 s71, s70
    s_waitcnt lgkmcnt(0)
    s_mov_b64 exec, 1
    ds_add_u32 v3, v4 offset:18484
    s_mov_b64 exec, -1
    s_mov_b32 s48, s38
    s_mov_b32 s49, s39
    s_mov_b32 s50, 1835008
    s_mov_b32 s51, 0x00020000
H_YPOLL:
    buffer_load_dwordx4 v[48:51], v8, s[44:47], s65 offen sc1
    buffer_load_dwordx4 v[52:55], v8, s[44:47], s65 offen offset:32 sc1
    s_waitcnt vmcnt(0)
    v_max_u32 v16, v48, v52
    v_cmp_eq_u32 vcc, -1, v16
    s_and_b64 vcc, vcc, s[70:71]
    s_cbranch_vccz H_YOK
    s_sub_u32 s61, s61, 1
    s_cbranch_scc1 BAIL
    s_sleep 8
    s_branch H_YPOLL
H_YOK:
    v_mfma_f32_32x32x16_bf16 v[64:79], v[48:51], v[40:43], 0
    v_mfma_f32_32x32x16_bf16 v[64:79], v[52:55], v[44:47], v[64:79]
    s_lshl_b32 s80, s3, 11
    v_add_u32 v17, s80, v14
    s_lshl_b32 s81, s4, 2
    s_add_u32 s81, s81, s5
    s_lshl_b32 s79, s81, 13
    s_add_u32 s80, s80, s79
    s_add_u32 s80, s80, 2621440
    s_lshl_b32 s81, s81, 8
    s_lshl_b32 s79, s3, 6
    s_add_u32 s81, s81, s79
    s_add_u32 s81, s81, 327680
    v_mov_b32 v18, s60
    s_setprio 3
    s_barrier
W45:
    ds_read_b32 v5, v3 offset:18512
    s_waitcnt lgkmcnt(0)
    v_readfirstlane_b32 s64, v5
    s_cmp_ge_u32 s64, 4
    s_cbranch_scc1 D46
    s_sub_u32 s61, s61, 1
    s_cbranch_scc1 BAIL
    s_branch W45
D46:
    ds_read_b128 v[96:99], v14 offset:0
    ds_read_b128 v[100:103], v14 offset:1024
    ds_read_b128 v[104:107], v14 offset:2048
    ds_read_b128 v[108:111], v14 offset:3072
    ds_read_b128 v[112:115], v14 offset:4096
    ds_read_b128 v[116:119], v14 offset:5120
    ds_read_b128 v[120:123], v14 offset:6144
    ds_read_b128 v[124:127], v14 offset:7168
    s_waitcnt lgkmcnt(7)
    v_mfma_f32_32x32x16_bf16 v[64:79], a[0:3], v[96:99], v[64:79]
    s_waitcnt lgkmcnt(6)
    v_mfma_f32_32x32x16_bf16 v[64:79], a[4:7], v[100:103], v[64:79]
    s_waitcnt lgkmcnt(5)
    v_mfma_f32_32x32x16_bf16 v[64:79], a[8:11], v[104:107], v[64:79]
    s_waitcnt lgkmcnt(4)
    v_mfma_f32_32x32x16_bf16 v[64:79], a[12:15], v[108:111], v[64:79]
    s_waitcnt lgkmcnt(3)
    v_mfma_f32_32x32x16_bf16 v[64:79], a[16:19], v[112:115], v[64:79]
    ds_read_b128 v[20:23], v3 offset:18512
    s_waitcnt lgkmcnt(3)
    v_mfma_f32_32x32x16_bf16 v[64:79], a[20:23], v[116:119], v[64:79]
    s_waitcnt lgkmcnt(2)
    v_mfma_f32_32x32x16_bf16 v[64:79], a[24:27], v[120:123], v[64:79]
    s_waitcnt lgkmcnt(1)
    v_mfma_f32_32x32x16_bf16 v[64:79], a[28:31], v[124:127], v[64:79]
    s_mov_b32 s79, 0x80000000
    s_cmp_eq_u32 s59, 0
    s_cbranch_scc1 H_NOX
    ds_read_b128 v[24:27], v17
    ds_read_b128 v[28:31], v17 offset:1024
    s_waitcnt lgkmcnt(0)
    buffer_store_dwordx4 v[24:27], v2, s[44:47], s80 offen sc1
    buffer_store_dwordx4 v[28:31], v2, s[44:47], s80 offen offset:1024 sc1
    s_mov_b32 s79, 24
H_NOX:
    s_mov_b32 s73, 14
    s_branch H_PICK2
H_PICK:
    ds_read_b128 v[20:23], v3 offset:18512
H_PICK2:
    s_waitcnt lgkmcnt(0)
    v_readfirstlane_b32 s76, v21
    v_readfirstlane_b32 s77, v22
    v_readfirstlane_b32 s78, v23
    s_lshr_b32 s76, s76, 1
    s_lshl_b32 s78, s78, 1
    s_and_b32 s76, s76, 2
    s_and_b32 s77, s77, 4
    s_and_b32 s78, s78, 8
    s_or_b32 s76, s76, s77
    s_or_b32 s76, s76, s78
    s_and_b32 s76, s76, s73
    s_cbranch_scc1 H_GO
    s_sub_u32 s61, s61, 1
    s_cbranch_scc1 BAIL
    s_sub_u32 s79, s79, 1
    s_cmp_lg_u32 s79, 0
    s_cbranch_scc1 H_PICK
    s_waitcnt vmcnt(0)
    s_mov_b64 exec, 1
    buffer_store_dword v18, v3, s[44:47], s81 offen sc1
    s_mov_b64 exec, -1
    s_mov_b32 s79, 0x80000000
    s_branch H_PICK
H_GO:
    s_xor_b32 s73, s73, s76
    s_cmp_eq_u32 s76, 2
    s_cbranch_scc1 H_B2
    s_cmp_eq_u32 s76, 4
    s_cbranch_scc1 H_B4
    s_cmp_eq_u32 s76, 8
    s_cbranch_scc1 H_B8
    s_cmp_eq_u32 s76, 6
    s_cbranch_scc1 H_B6
    s_cmp_eq_u32 s76, 10
    s_cbranch_scc1 H_B10
    s_cmp_eq_u32 s76, 12
    s_cbranch_scc1 H_B12
H_B14:
    ds_read_b128 v[96:99], v14 offset:8192
    ds_read_b128 v[100:103], v14 offset:9216
    ds_read_b128 v[104:107], v14 offset:10240
    ds_read_b128 v[108:111], v14 offset:11264
    ds_read_b128 v[112:115], v14 offset:12288
    ds_read_b128 v[116:119], v14 offset:13312
    ds_read_b128 v[120:123], v14 offset:14336
    ds_read_b128 v[124:127], v14 offset:15360
    ds_read_b128 a[0:3], v14 offset:16384
    ds_read_b128 a[4:7], v14 offset:17408
    ds_read_b128 a[8:11], v14 offset:18432
    ds_read_b128 a[12:15], v14 offset:19456
    s_waitcnt lgkmcnt(11)
    v_mfma_f32_32x32x16_bf16 v[32:47], a[32:35], v[96:99], 0
    ds_read_b128 a[16:19], v14 offset:20480
    s_waitcnt lgkmcnt(11)
    v_mfma_f32_32x32x16_bf16 v[32:47], a[36:39], v[100:103], v[32:47]
    ds_read_b128 a[20:23], v14 offset:21504
    s_waitcnt lgkmcnt(11)
    v_mfma_f32_32x32x16_bf16 v[32:47], a[40:43], v[104:107], v[32:47]
    ds_read_b128 a[24:27], v14 offset:22528
    s_waitcnt lgkmcnt(11)
    v_mfma_f32_32x32x16_bf16 v[32:47], a[44:47], v[108:111], v[32:47]
    ds_read_b128 a[28:31], v14 offset:23552
    s_waitcnt lgkmcnt(11)
    v_mfma_f32_32x32x16_bf16 v[32:47], a[48:51], v[112:115], v[32:47]
    ds_read_b128 v[96:99], v14 offset:24576
    s_waitcnt lgkmcnt(11)
    v_mfma_f32_32x32x16_bf16 v[32:47], a[52:55], v[116:119], v[32:47]
    ds_read_b128 v[100:103], v14 offset:25600
    s_waitcnt lgkmcnt(11)
    v_mfma_f32_32x32x16_bf16 v[32:47], a[56:59], v[120:123], v[32:47]
    ds_read_b128 v[104:107], v14 offset:26624
    s_waitcnt lgkmcnt(11)
    v_mfma_f32_32x32x16_bf16 v[32:47], a[60:63], v[124:127], v[32:47]
    ds_read_b128 v[108:111], v14 offset:27648
    s_waitcnt lgkmcnt(11)
    v_mfma_f32_32x32x16_bf16 v[48:63], a[64:67], a[0:3], 0
    ds_read_b128 v[112:115], v14 offset:28672
    s_waitcnt lgkmcnt(11)
    v_mfma_f32_32x32x16_bf16 v[48:63], a[68:71], a[4:7], v[48:63]
    ds_read_b128 v[116:119], v14 offset:29696
    s_waitcnt lgkmcnt(11)
    v_mfma_f32_32x32x16_bf16 v[48:63], a[72:75], a[8:11], v[48:63]
    ds_read_b128 v[120:123], v14 offset:30720
    s_waitcnt lgkmcnt(11)
    v_mfma_f32_32x32x16_bf16 v[48:63], a[76:79], a[12:15], v[48:63]
    ds_read_b128 v[124:127], v14 offset:31744
    s_waitcnt lgkmcnt(11)
    v_mfma_f32_32x32x16_bf16 v[48:63], a[80:83], a[16:19], v[48:63]
    s_waitcnt lgkmcnt(10)
    v_mfma_f32_32x32x16_bf16 v[48:63], a[84:87], a[20:23], v[48:63]
    s_waitcnt lgkmcnt(9)
    v_mfma_f32_32x32x16_bf16 v[48:63], a[88:91], a[24:27], v[48:63]
    s_waitcnt lgkmcnt(8)
    v_mfma_f32_32x32x16_bf16 v[48:63], a[92:95], a[28:31], v[48:63]
    s_waitcnt lgkmcnt(7)
    v_mfma_f32_32x32x16_bf16 v[80:95], a[96:99], v[96:99], 0
    s_waitcnt lgkmcnt(6)
    v_mfma_f32_32x32x16_bf16 v[80:95], a[100:103], v[100:103], v[80:95]
    s_waitcnt lgkmcnt(5)
    v_mfma_f32_32x32x16_bf16 v[80:95], a[104:107], v[104:107], v[80:95]
    s_waitcnt lgkmcnt(4)
    v_mfma_f32_32x32x16_bf16 v[80:95], a[108:111], v[108:111], v[80:95]
    s_waitcnt lgkmcnt(3)
    v_mfma_f32_32x32x16_bf16 v[80:95], a[112:115], v[112:115], v[80:95]
    s_waitcnt lgkmcnt(2)
    v_mfma_f32_32x32x16_bf16 v[80:95], a[116:119], v[116:119], v[80:95]
    s_waitcnt lgkmcnt(1)
    v_mfma_f32_32x32x16_bf16 v[80:95], a[120:123], v[120:123], v[80:95]
    s_waitcnt lgkmcnt(0)
    v_mfma_f32_32x32x16_bf16 v[80:95], a[124:127], v[124:127], v[80:95]
    s_branch H_FIN
H_B12:
    ds_read_b128 v[96:99], v14 offset:16384
    ds_read_b128 v[100:103], v14 offset:17408
    ds_read_b128 v[104:107], v14 offset:18432
    ds_read_b128 v[108:111], v14 offset:19456
    ds_read_b128 v[112:115], v14 offset:20480
    ds_read_b128 v[116:119], v14 offset:21504
    ds_read_b128 v[120:123], v14 offset:22528
    ds_read_b128 v[124:127], v14 offset:23552
    ds_read_b128 a[0:3], v14 offset:24576
    ds_read_b128 a[4:7], v14 offset:25600
    ds_read_b128 a[8:11], v14 offset:26624
    ds_read_b128 a[12:15], v14 offset:27648
    s_waitcnt lgkmcnt(11)
    v_mfma_f32_32x32x16_bf16 v[48:63], a[64:67], v[96:99], 0
    ds_read_b128 a[16:19], v14 offset:28672
    s_waitcnt lgkmcnt(11)
    v_mfma_f32_32x32x16_bf16 v[48:63], a[68:71], v[100:103], v[48:63]
    ds_read_b128 a[20:23], v14 offset:29696
    s_waitcnt lgkmcnt(11)
    v_mfma_f32_32x32x16_bf16 v[48:63], a[72:75], v[104:107], v[48:63]
    ds_read_b128 a[24:27], v14 offset:30720
    s_waitcnt lgkmcnt(11)
    v_mfma_f32_32x32x16_bf16 v[48:63], a[76:79], v[108:111], v[48:63]
    ds_read_b128 a[28:31], v14 offset:31744
    s_waitcnt lgkmcnt(11)
    v_mfma_f32_32x32x16_bf16 v[48:63], a[80:83], v[112:115], v[48:63]
    s_waitcnt lgkmcnt(10)
    v_mfma_f32_32x32x16_bf16 v[48:63], a[84:87], v[116:119], v[48:63]
    s_waitcnt lgkmcnt(9)
    v_mfma_f32_32x32x16_bf16 v[48:63], a[88:91], v[120:123], v[48:63]
    s_waitcnt lgkmcnt(8)
    v_mfma_f32_32x32x16_bf16 v[48:63], a[92:95], v[124:127], v[48:63]
    s_waitcnt lgkmcnt(7)
    v_mfma_f32_32x32x16_bf16 v[80:95], a[96:99], a[0:3], 0
    s_waitcnt lgkmcnt(6)
    v_mfma_f32_32x32x16_bf16 v[80:95], a[100:103], a[4:7], v[80:95]
    s_waitcnt lgkmcnt(5)
    v_mfma_f32_32x32x16_bf16 v[80:95], a[104:107], a[8:11], v[80:95]
    s_waitcnt lgkmcnt(4)
    v_mfma_f32_32x32x16_bf16 v[80:95], a[108:111], a[12:15], v[80:95]
    s_waitcnt lgkmcnt(3)
    v_mfma_f32_32x32x16_bf16 v[80:95], a[112:115], a[16:19], v[80:95]
    ds_read_b128 v[20:23], v3 offset:18512
    s_waitcnt lgkmcnt(3)
    v_mfma_f32_32x32x16_bf16 v[80:95], a[116:119], a[20:23], v[80:95]
    s_waitcnt lgkmcnt(2)
    v_mfma_f32_32x32x16_bf16 v[80:95], a[120:123], a[24:27], v[80:95]
    s_waitcnt lgkmcnt(1)
    v_mfma_f32_32x32x16_bf16 v[80:95], a[124:127], a[28:31], v[80:95]
    s_cmp_lg_u32 s73, 0
    s_cbranch_scc1 H_PICK2
    s_branch H_FIN
H_B10:
    ds_read_b128 v[96:99], v14 offset:8192
    ds_read_b128 v[100:103], v14 offset:9216
    ds_read_b128 v[104:107], v14 offset:10240
    ds_read_b128 v[108:111], v14 offset:11264
    ds_read_b128 v[112:115], v14 offset:12288
    ds_read_b128 v[116:119], v14 offset:13312
    ds_read_b128 v[120:123], v14 offset:14336
    ds_read_b128 v[124:127], v14 offset:15360
    ds_read_b128 a[0:3], v14 offset:24576
    ds_read_b128 a[4:7], v14 offset:25600
    ds_read_b128 a[8:11], v14 offset:26624
    ds_read_b128 a[12:15], v14 offset:27648
    s_waitcnt lgkmcnt(11)
    v_mfma_f32_32x32x16_bf16 v[32:47], a[32:35], v[96:99], 0
    ds_read_b128 a[16:19], v14 offset:28672
    s_waitcnt lgkmcnt(11)
    v_mfma_f32_32x32x16_bf16 v[32:47], a[36:39], v[100:103], v[32:47]
    ds_read_b128 a[20:23], v14 offset:29696
    s_waitcnt lgkmcnt(11)
    v_mfma_f32_32x32x16_bf16 v[32:47], a[40:43], v[104:107], v[32:47]
    ds_read_b128 a[24:27], v14 offset:30720
    s_waitcnt lgkmcnt(11)
    v_mfma_f32_32x32x16_bf16 v[32:47], a[44:47], v[108:111], v[32:47]
    ds_read_b128 a[28:31], v14 offset:31744
    s_waitcnt lgkmcnt(11)
    v_mfma_f32_32x32x16_bf16 v[32:47], a[48:51], v[112:115], v[32:47]
    s_waitcnt lgkmcnt(10)
    v_mfma_f32_32x32x16_bf16 v[32:47], a[52:55], v[116:119], v[32:47]
    s_waitcnt lgkmcnt(9)
    v_mfma_f32_32x32x16_bf16 v[32:47], a[56:59], v[120:123], v[32:47]
    s_waitcnt lgkmcnt(8)
    v_mfma_f32_32x32x16_bf16 v[32:47], a[60:63], v[124:127], v[32:47]
    s_waitcnt lgkmcnt(7)
    v_mfma_f32_32x32x16_bf16 v[80:95], a[96:99], a[0:3], 0
    s_waitcnt lgkmcnt(6)
    v_mfma_f32_32x32x16_bf16 v[80:95], a[100:103], a[4:7], v[80:95]
    s_waitcnt lgkmcnt(5)
    v_mfma_f32_32x32x16_bf16 v[80:95], a[104:107], a[8:11], v[80:95]
    s_waitcnt lgkmcnt(4)
    v_mfma_f32_32x32x16_bf16 v[80:95], a[108:111], a[12:15], v[80:95]
    s_waitcnt lgkmcnt(3)
    v_mfma_f32_32x32x16_bf16 v[80:95], a[112:115], a[16:19], v[80:95]
    ds_read_b128 v[20:23], v3 offset:18512
    s_waitcnt lgkmcnt(3)
    v_mfma_f32_32x32x16_bf16 v[80:95], a[116:119], a[20:23], v[80:95]
    s_waitcnt lgkmcnt(2)
    v_mfma_f32_32x32x16_bf16 v[80:95], a[120:123], a[24:27], v[80:95]
    s_waitcnt lgkmcnt(1)
    v_mfma_f32_32x32x16_bf16 v[80:95], a[124:127], a[28:31], v[80:95]
    s_cmp_lg_u32 s73, 0
    s_cbranch_scc1 H_PICK2
    s_branch H_FIN
H_B6:
    ds_read_b128 v[96:99], v14 offset:8192
    ds_read_b128 v[100:103], v14 offset:9216
    ds_read_b128 v[104:107], v14 offset:10240
    ds_read_b128 v[108:111], v14 offset:11264
    ds_read_b128 v[112:115], v14 offset:12288
    ds_read_b128 v[116:119], v14 offset:13312
    ds_read_b128 v[120:123], v14 offset:14336
    ds_read_b128 v[124:127], v14 offset:15360
    ds_read_b128 a[0:3], v14 offset:16384
    ds_read_b128 a[4:7], v14 offset:17408
    ds_read_b128 a[8:11], v14 offset:18432
    ds_read_b128 a[12:15], v14 offset:19456
    s_waitcnt lgkmcnt(11)
    v_mfma_f32_32x32x16_bf16 v[32:47], a[32:35], v[96:99], 0
    ds_read_b128 a[16:19], v14 offset:20480
    s_waitcnt lgkmcnt(11)
    v_mfma_f32_32x32x16_bf16 v[32:47], a[36:39], v[100:103], v[32:47]
    ds_read_b128 a[20:23], v14 offset:21504
    s_waitcnt lgkmcnt(11)
    v_mfma_f32_32x32x16_bf16 v[32:47], a[40:43], v[104:107], v[32:47]
    ds_read_b128 a[24:27], v14 offset:22528
    s_waitcnt lgkmcnt(11)
    v_mfma_f32_32x32x16_bf16 v[32:47], a[44:47], v[108:111], v[32:47]
    ds_read_b128 a[28:31], v14 offset:23552
    s_waitcnt lgkmcnt(11)
    v_mfma_f32_32x32x16_bf16 v[32:47], a[48:51], v[112:115], v[32:47]
    s_waitcnt lgkmcnt(10)
    v_mfma_f32_32x32x16_bf16 v[32:47], a[52:55], v[116:119], v[32:47]
    s_waitcnt lgkmcnt(9)
    v_mfma_f32_32x32x16_bf16 v[32:47], a[56:59], v[120:123], v[32:47]
    s_waitcnt lgkmcnt(8)
    v_mfma_f32_32x32x16_bf16 v[32:47], a[60:63], v[124:127], v[32:47]
    s_waitcnt lgkmcnt(7)
    v_mfma_f32_32x32x16_bf16 v[48:63], a[64:67], a[0:3], 0
    s_waitcnt lgkmcnt(6)
    v_mfma_f32_32x32x16_bf16 v[48:63], a[68:71], a[4:7], v[48:63]
    s_waitcnt lgkmcnt(5)
    v_mfma_f32_32x32x16_bf16 v[48:63], a[72:75], a[8:11], v[48:63]
    s_waitcnt lgkmcnt(4)
    v_mfma_f32_32x32x16_bf16 v[48:63], a[76:79], a[12:15], v[48:63]
    s_waitcnt lgkmcnt(3)
    v_mfma_f32_32x32x16_bf16 v[48:63], a[80:83], a[16:19], v[48:63]
    ds_read_b128 v[20:23], v3 offset:18512
    s_waitcnt lgkmcnt(3)
    v_mfma_f32_32x32x16_bf16 v[48:63], a[84:87], a[20:23], v[48:63]
    s_waitcnt lgkmcnt(2)
    v_mfma_f32_32x32x16_bf16 v[48:63], a[88:91], a[24:27], v[48:63]
    s_waitcnt lgkmcnt(1)
    v_mfma_f32_32x32x16_bf16 v[48:63], a[92:95], a[28:31], v[48:63]
    s_cmp_lg_u32 s73, 0
    s_cbranch_scc1 H_PICK2
    s_branch H_FIN
H_B8:
    ds_read_b128 v[96:99], v14 offset:24576
    ds_read_b128 v[100:103], v14 offset:25600
    ds_read_b128 v[104:107], v14 offset:26624
    ds_read_b128 v[108:111], v14 offset:27648
    ds_read_b128 v[112:115], v14 offset:28672
    ds_read_b128 v[116:119], v14 offset:29696
    ds_read_b128 v[120:123], v14 offset:30720
    ds_read_b128 v[124:127], v14 offset:31744
    s_waitcnt lgkmcnt(7)
    v_mfma_f32_32x32x16_bf16 v[80:95], a[96:99], v[96:99], 0
    s_waitcnt lgkmcnt(6)
    v_mfma_f32_32x32x16_bf16 v[80:95], a[100:103], v[100:103], v[80:95]
    s_waitcnt lgkmcnt(5)
    v_mfma_f32_32x32x16_bf16 v[80:95], a[104:107], v[104:107], v[80:95]
    s_waitcnt lgkmcnt(4)
    v_mfma_f32_32x32x16_bf16 v[80:95], a[108:111], v[108:111], v[80:95]
    s_waitcnt lgkmcnt(3)
    v_mfma_f32_32x32x16_bf16 v[80:95], a[112:115], v[112:115], v[80:95]
    ds_read_b128 v[20:23], v3 offset:18512
    s_waitcnt lgkmcnt(3)
    v_mfma_f32_32x32x16_bf16 v[80:95], a[116:119], v[116:119], v[80:95]
    s_waitcnt lgkmcnt(2)
    v_mfma_f32_32x32x16_bf16 v[80:95], a[120:123], v[120:123], v[80:95]
    s_waitcnt lgkmcnt(1)
    v_mfma_f32_32x32x16_bf16 v[80:95], a[124:127], v[124:127], v[80:95]
    s_cmp_lg_u32 s73, 0
    s_cbranch_scc1 H_PICK2
    s_branch H_FIN
H_B4:
    ds_read_b128 v[96:99], v14 offset:16384
    ds_read_b128 v[100:103], v14 offset:17408
    ds_read_b128 v[104:107], v14 offset:18432
    ds_read_b128 v[108:111], v14 offset:19456
    ds_read_b128 v[112:115], v14 offset:20480
    ds_read_b128 v[116:119], v14 offset:21504
    ds_read_b128 v[120:123], v14 offset:22528
    ds_read_b128 v[124:127], v14 offset:23552
    s_waitcnt lgkmcnt(7)
    v_mfma_f32_32x32x16_bf16 v[48:63], a[64:67], v[96:99], 0
    s_waitcnt lgkmcnt(6)
    v_mfma_f32_32x32x16_bf16 v[48:63], a[68:71], v[100:103], v[48:63]
    s_waitcnt lgkmcnt(5)
    v_mfma_f32_32x32x16_bf16 v[48:63], a[72:75], v[104:107], v[48:63]
    s_waitcnt lgkmcnt(4)
    v_mfma_f32_32x32x16_bf16 v[48:63], a[76:79], v[108:111], v[48:63]
    s_waitcnt lgkmcnt(3)
    v_mfma_f32_32x32x16_bf16 v[48:63], a[80:83], v[112:115], v[48:63]
    ds_read_b128 v[20:23], v3 offset:18512
    s_waitcnt lgkmcnt(3)
    v_mfma_f32_32x32x16_bf16 v[48:63], a[84:87], v[116:119], v[48:63]
    s_waitcnt lgkmcnt(2)
    v_mfma_f32_32x32x16_bf16 v[48:63], a[88:91], v[120:123], v[48:63]
    s_waitcnt lgkmcnt(1)
    v_mfma_f32_32x32x16_bf16 v[48:63], a[92:95], v[124:127], v[48:63]
    s_cmp_lg_u32 s73, 0
    s_cbranch_scc1 H_PICK2
    s_branch H_FIN
H_B2:
    ds_read_b128 v[96:99], v14 offset:8192
    ds_read_b128 v[100:103], v14 offset:9216
    ds_read_b128 v[104:107], v14 offset:10240
    ds_read_b128 v[108:111], v14 offset:11264
    ds_read_b128 v[112:115], v14 offset:12288
    ds_read_b128 v[116:119], v14 offset:13312
    ds_read_b128 v[120:123], v14 offset:14336
    ds_read_b128 v[124:127], v14 offset:15360
    s_waitcnt lgkmcnt(7)
    v_mfma_f32_32x32x16_bf16 v[32:47], a[32:35], v[96:99], 0
    s_waitcnt lgkmcnt(6)
    v_mfma_f32_32x32x16_bf16 v[32:47], a[36:39], v[100:103], v[32:47]
    s_waitcnt lgkmcnt(5)
    v_mfma_f32_32x32x16_bf16 v[32:47], a[40:43], v[104:107], v[32:47]
    s_waitcnt lgkmcnt(4)
    v_mfma_f32_32x32x16_bf16 v[32:47], a[44:47], v[108:111], v[32:47]
    s_waitcnt lgkmcnt(3)
    v_mfma_f32_32x32x16_bf16 v[32:47], a[48:51], v[112:115], v[32:47]
    ds_read_b128 v[20:23], v3 offset:18512
    s_waitcnt lgkmcnt(3)
    v_mfma_f32_32x32x16_bf16 v[32:47], a[52:55], v[116:119], v[32:47]
    s_waitcnt lgkmcnt(2)
    v_mfma_f32_32x32x16_bf16 v[32:47], a[56:59], v[120:123], v[32:47]
    s_waitcnt lgkmcnt(1)
    v_mfma_f32_32x32x16_bf16 v[32:47], a[60:63], v[124:127], v[32:47]
    s_cmp_lg_u32 s73, 0
    s_cbranch_scc1 H_PICK2
H_FIN:
    s_cmp_gt_u32 s79, 24
    s_cbranch_scc1 H_FL
    s_waitcnt vmcnt(0)
    s_mov_b64 exec, 1
    buffer_store_dword v18, v3, s[44:47], s81 offen sc1
    s_mov_b64 exec, -1
H_FL:
    s_nop 8
    v_pk_add_f32 v[32:33], v[32:33], v[48:49]
    v_pk_add_f32 v[34:35], v[34:35], v[50:51]
    v_pk_add_f32 v[36:37], v[36:37], v[52:53]
    v_pk_add_f32 v[38:39], v[38:39], v[54:55]
    v_pk_add_f32 v[40:41], v[40:41], v[56:57]
    v_pk_add_f32 v[42:43], v[42:43], v[58:59]
    v_pk_add_f32 v[44:45], v[44:45], v[60:61]
    v_pk_add_f32 v[46:47], v[46:47], v[62:63]
    v_pk_add_f32 v[64:65], v[64:65], v[80:81]
    v_pk_add_f32 v[66:67], v[66:67], v[82:83]
    v_pk_add_f32 v[68:69], v[68:69], v[84:85]
    v_pk_add_f32 v[70:71], v[70:71], v[86:87]
    v_pk_add_f32 v[72:73], v[72:73], v[88:89]
    v_pk_add_f32 v[74:75], v[74:75], v[90:91]
    v_pk_add_f32 v[76:77], v[76:77], v[92:93]
    v_pk_add_f32 v[78:79], v[78:79], v[94:95]
    v_pk_add_f32 v[64:65], v[64:65], v[32:33]
    v_pk_add_f32 v[66:67], v[66:67], v[34:35]
    v_pk_add_f32 v[68:69], v[68:69], v[36:37]
    v_pk_add_f32 v[70:71], v[70:71], v[38:39]
    v_pk_add_f32 v[72:73], v[72:73], v[40:41]
    v_pk_add_f32 v[74:75], v[74:75], v[42:43]
    v_pk_add_f32 v[76:77], v[76:77], v[44:45]
    v_pk_add_f32 v[78:79], v[78:79], v[46:47]
    v_cvt_pk_bf16_f32 v32, v64, v65
    v_cvt_pk_bf16_f32 v33, v66, v67
    v_cvt_pk_bf16_f32 v34, v68, v69
    v_cvt_pk_bf16_f32 v35, v70, v71
    v_cvt_pk_bf16_f32 v36, v72, v73
    v_cvt_pk_bf16_f32 v37, v74, v75
    v_cvt_pk_bf16_f32 v38, v76, v77
    v_cvt_pk_bf16_f32 v39, v78, v79
    s_cmp_eq_u32 s3, 3
    s_nop 0
    v_permlane32_swap_b32 v32, v34
    v_permlane32_swap_b32 v33, v35
    v_permlane32_swap_b32 v36, v38
    v_permlane32_swap_b32 v37, v39
    buffer_store_dwordx4 v[32:35], v12, s[48:51], s66 offen
    s_cbranch_scc1 H_END
    buffer_store_dwordx4 v[36:39], v12, s[48:51], s66 offen offset:32
H_END:
BAIL:
    s_endpgm
CODE_END:
.section .rodata,"a"
.p2align 6
.amdhsa_kernel gated_mix__grouped_kv_mqa__ssm_conv_s4__prompt_kernel
  .amdhsa_next_free_vgpr 256
  .amdhsa_next_free_sgpr 102
  .amdhsa_accum_offset 128
  .amdhsa_group_segment_fixed_size 0
  .amdhsa_kernarg_size 144
  .amdhsa_user_sgpr_count 2
  .amdhsa_user_sgpr_kernarg_segment_ptr 1
  .amdhsa_system_sgpr_workgroup_id_x 1
.end_amdhsa_kernel
```
